```python
import torch

def _softmax(x, axis=-1):
    return torch.softmax(x, dim=axis)

def _gelu(x):
    return torch.nn.functional.gelu(x, approximate='tanh')

def _silu(x):
    return torch.nn.functional.silu(x)

def _sigmoid(x):
    return torch.sigmoid(x)

def _layernorm(x, axis=-1, eps=1e-05):
    m = x.mean(dim=axis, keepdim=True)
    v = x.var(dim=axis, keepdim=True, unbiased=False)
    return (x - m) / torch.sqrt(v + eps)

def _scatter_add(tgt, idx, src, axis=0):
    return tgt.clone().index_add_(axis, idx, src)

def _segment_sum(src, seg, n):
    out = torch.zeros((n,) + src.shape[1:], dtype=src.dtype)
    return out.index_add_(0, seg, src)

def _pad(x, pw):
    flat = tuple((v for pair in reversed(pw) for v in pair))
    return torch.nn.functional.pad(x, flat)
kernel_name = 'adaLN_cond__ssm_conv_h3__moe_arch_mod__prompt'

def setup_inputs():

    _w = lambda a: (lambda t: t.to(torch.bfloat16) if t.is_floating_point() else t)(torch.as_tensor(a))

    def _A_setup():
        B, S, D = (1, 2048, 640)
        ks = 4
        return {'q': _w((lambda *s: torch.randn(*s, dtype=torch.bfloat16) * 0.05)(B, S, D)), 'k': _w((lambda *s: torch.randn(*s, dtype=torch.bfloat16) * 0.4)(B, S, D)), 'v': _w((lambda *s: torch.randn(*s, dtype=torch.bfloat16) * 0.4)(B, S, D)), 'shift_k': _w((lambda *s: torch.randn(*s, dtype=torch.bfloat16) * 0.4)(D, ks) * 0.5), 'ssm_k': _w((lambda *s: torch.randn(*s, dtype=torch.bfloat16) * 0.8)(D, S) * (1.0 / S ** 0.5)), 'ssm_D': _w((lambda *s: torch.randn(*s, dtype=torch.bfloat16) * 0.4)(D))}
    _A_in = _A_setup()

    def _B_setup():
        B, S, D, F, C = (1, 2048, 640, 1728, 1)
        return {'x': _w((lambda *s: torch.randn(*s, dtype=torch.bfloat16) * 0.05)(B, S, D)), 'w_r': _w((lambda *s: torch.randn(*s, dtype=torch.bfloat16) * 0.05)(D)), 'w_gate': _w((lambda *s: torch.randn(*s, dtype=torch.bfloat16) * 0.05)(D, F)), 'w_up': _w((lambda *s: torch.randn(*s, dtype=torch.bfloat16) * 0.05)(D, F)), 'w_down': _w((lambda *s: torch.randn(*s, dtype=torch.bfloat16) * 0.05)(F, D))}
    _B_in = _B_setup()
    return {'A_q': _A_in['q'], 'A_k': _A_in['k'], 'A_v': _A_in['v'], 'A_shift_k': _A_in['shift_k'], 'A_ssm_k': _A_in['ssm_k'], 'A_ssm_D': _A_in['ssm_D'], 'B_x': _B_in['x'], 'B_w_r': _B_in['w_r'], 'B_w_gate': _B_in['w_gate'], 'B_w_up': _B_in['w_up'], 'B_w_down': _B_in['w_down'], 'c': _w((lambda *s: torch.randn(*s, dtype=torch.bfloat16) * 0.2)(1, 640) * 8.0), 'w_mod': _w((lambda *s: torch.randn(*s, dtype=torch.bfloat16) * 0.2)(640, 6 * 640) * 640 ** (-0.5) * 8.0)}

def reference(A_q, A_k, A_v, A_shift_k, A_ssm_k, A_ssm_D, B_x, B_w_r, B_w_gate, B_w_up, B_w_down, c, w_mod):

    def _A_ref(q, k, v, shift_k, ssm_k, ssm_D):
        B, S, D = q.shape
        ks = shift_k.shape[-1]
        k_pad = _pad(k, ((0, 0), (ks - 1, 0), (0, 0)))
        k_shift = torch.zeros_like(k)
        for t in range(ks):
            k_shift = k_shift + k_pad[:, t:t + S, :] * shift_k[:, ks - 1 - t][None, None, :]
        kv = k_shift * v
        L = 2 * S
        kv_pad = _pad(kv, ((0, 0), (0, S), (0, 0)))
        kf_pad = _pad(ssm_k, ((0, 0), (0, S)))
        kv_f = (lambda x, axes=(-2, -1): torch.fft.rfft2(x.float(), dim=axes))(kv_pad[:, None, :, :], axes=(1, 2))
        kf_f = (lambda x, axes=(-2, -1): torch.fft.rfft2(x.float(), dim=axes))(kf_pad[:, None, :], axes=(1, 2))
        kf_f = (lambda x, *d: x.permute(*d))(kf_f, 1, 2, 0)
        y_f = kv_f * kf_f[None, :, :, :]
        y = (lambda x, s, axes=(-2, -1): torch.fft.irfft2(x, s=s, dim=axes).to(torch.bfloat16))(y_f, (1, L), axes=(1, 2))[:, 0, :S, :]
        y = y + kv * ssm_D[None, None, :]
        return q * y

    def _B_ref(x, w_r, w_gate, w_up, w_down):
        B, S, D = x.shape
        C = 1
        r = x @ w_r
        idx = torch.argsort(-r, axis=-1)[:, :C]
        idx_e = (lambda x, n, axis: torch.repeat_interleave(x, n, dim=axis))(idx.reshape(B, C, 1), D, axis=2)
        x_sel = (lambda x, i, axis: torch.take_along_dim(x, i, dim=axis))(x, idx_e, axis=1)
        g = _silu(x_sel @ w_gate)
        u = x_sel @ w_up
        y = g * u @ w_down
        r_sel = _sigmoid((lambda x, i, axis: torch.take_along_dim(x, i, dim=axis))(r, idx, axis=1))
        y = y * r_sel.reshape(B, C, 1)
        b_off = (torch.arange(B) * S).reshape(B, 1)
        flat_idx = (idx + b_off).reshape(B * C)
        zero = (x * 0.0).reshape(B * S, D)
        upd = _scatter_add(zero, flat_idx, y.reshape(B * C, D), axis=0)
        return x + upd.reshape(B, S, D)
    x = A_q
    mod = (_silu(c) @ w_mod).reshape(c.shape[0], 6, 1, -1)
    sa, ca, ga, sb, cb, gb = (mod[:, 0].clone(), mod[:, 1].clone(), mod[:, 2].clone(), mod[:, 3].clone(), mod[:, 4].clone(), mod[:, 5].clone())
    h = _layernorm(x, axis=-1) * (1 + ca) + sa
    x = x + ga * _A_ref(h, A_k, A_v, A_shift_k, A_ssm_k, A_ssm_D)
    h = _layernorm(x, axis=-1) * (1 + cb) + sb
    x = x + gb * _B_ref(h, B_w_r, B_w_gate, B_w_up, B_w_down)
    return x
```

```asm
; @launch grid=(256,1,1) block=(256,1,1) lds=111616
.amdgcn_target "amdgcn-amd-amdhsa--gfx950"
.text
.globl adaLN_cond__ssm_conv_h3__moe_arch_mod__prompt_kernel
.p2align 12
.p2align 8
.type adaLN_cond__ssm_conv_h3__moe_arch_mod__prompt_kernel,@function
adaLN_cond__ssm_conv_h3__moe_arch_mod__prompt_kernel:
    s_load_dwordx16 s[4:19], s[0:1], 0
    s_load_dwordx16 s[20:35], s[0:1], 64
    s_cmp_ge_u32 s2, 256
    s_cbranch_scc1 L_end
    v_lshrrev_b32 v2, 6, v0
    v_and_b32 v1, 63, v0
    s_and_b32 s82, s2, 0xf8
    v_readfirstlane_b32 s74, v2
    s_getpc_b64 s[60:61]
L_pc:
    v_add_lshl_u32 v3, v1, s82, 7
    v_min_u32 v3, role_tab+380-L_pc, v3
    s_cmp_eq_u32 s74, 3
    s_cbranch_scc0 L_nopf
    s_mov_b64 exec, 0xff
    global_load_dword v254, v3, s[60:61]
    s_mov_b64 exec, -1
L_nopf:
    s_and_b32 s72, s2, 7
    s_lshr_b32 s73, s2, 3
    s_cmp_lt_u32 s73, 20
    s_cselect_b32 s99, 1, 0
    s_add_u32 s101, s73, 12
    s_and_b32 s101, s101, 31
    s_lshl_b32 s82, s101, 2
    s_add_u32 s82, s82, s74
    s_mul_i32 s82, s82, 20480
    s_mul_i32 s83, s72, 160
    s_add_u32 s82, s82, s83
    v_mul_u32_u24 v2, 26, v1
    v_lshrrev_b32 v2, 8, v2
    v_mul_u32_u24 v2, 1120, v2
    v_lshl_add_u32 v2, v1, 4, v2
    v_add_u32 v4, s82, v2
    v_subrev_u32 v5, 5120, v4
    s_lshl_b32 s83, s83, 2
    v_lshl_add_u32 v6, v1, 4, s83
    s_movk_i32 s76, 4464
    s_movk_i32 s77, 8928
    s_movk_i32 s78, 13392
    s_mov_b32 s38, 2621440
    s_mov_b32 s39, 0x20000
    s_mov_b64 s[42:43], s[38:39]
    s_mov_b64 s[58:59], s[38:39]
    s_movk_i32 s66, 5120
    s_mov_b32 s67, s39
    s_mul_i32 s3, s72, 20
    s_add_u32 s3, s3, s73
    s_lshl_b32 s82, s3, 2
    s_add_u32 s82, s82, s74
    s_lshl_b32 s84, s82, 12
    v_lshl_add_u32 v8, v1, 4, s84
    s_getreg_b32 s96, hwreg(HW_REG_XCC_ID, 0, 4)
    s_bitset1_b32 s96, 7
    s_lshl_b32 s86, s72, 5
    s_xor_b32 s85, s86, 64
    s_add_u32 s84, s86, s73
    v_mov_b32 v12, s96
    v_mov_b32 v13, s84
    s_mul_i32 s87, s74, 2624
    s_add_u32 s87, s87, 89744
    s_mov_b32 m0, 89088
    s_cmp_lg_u32 s74, 0
    s_waitcnt lgkmcnt(0)
    s_load_dword s100, s[32:33], s85
    s_load_dword s75, s[34:35], 0
    s_mov_b64 s[56:57], s[12:13]
    s_mov_b64 s[36:37], s[6:7]
    s_mov_b64 s[40:41], s[8:9]
    s_mov_b64 s[64:65], s[10:11]
    s_cbranch_scc1 L_ld_f
    s_mov_b64 exec, 1
    global_store_byte v13, v12, s[32:33]
    s_mov_b32 exec_lo, -1
    s_mov_b32 exec_hi, 0xff
    buffer_load_dwordx4 v5, s[36:39], 0 offen lds
    s_mov_b32 m0, 110848
    s_nop 0
    buffer_load_dwordx4 v6, s[64:67], 0 offen lds
    s_mov_b32 exec_hi, -1
L_ld_f:
    s_cmp_eq_u32 s99, 0
    s_cbranch_scc0 L_c0
    s_mov_b32 m0, s87
    s_mov_b32 exec_hi, 0xff
    buffer_load_dwordx4 v4, s[36:39], 0 offen offset:0 lds
    buffer_load_dwordx4 v4, s[36:39], s76 offen offset:656 lds
    buffer_load_dwordx4 v4, s[36:39], s77 offen offset:1312 lds
    buffer_load_dwordx4 v4, s[36:39], s78 offen offset:1968 lds
    s_add_u32 m0, m0, 10496
    s_mov_b32 exec_hi, -1
    s_mov_b32 exec_hi, 0xff
    buffer_load_dwordx4 v4, s[40:43], 0 offen offset:0 lds
    buffer_load_dwordx4 v4, s[40:43], s76 offen offset:656 lds
    buffer_load_dwordx4 v4, s[40:43], s77 offen offset:1312 lds
    buffer_load_dwordx4 v4, s[40:43], s78 offen offset:1968 lds
    s_mov_b32 exec_hi, -1
    s_branch L_nconv
L_c0:
    s_lshl_b32 s84, s73, 2
    s_add_u32 s84, s84, s74
    s_mul_i32 s84, s84, 12800
    s_lshr_b32 s85, s83, 2
    s_and_b32 s85, s85, -128
    s_add_u32 s84, s84, s85
    v_lshrrev_b32 v2, 1, v1
    v_lshlrev_b32 v2, 10, v2
    v_lshl_add_u32 v2, v1, 7, v2
    s_mov_b64 exec, 0xfffff
    buffer_load_dword v253, v2, s[40:43], s84 offen
    s_mov_b64 exec, -1
    s_lshr_b32 s82, s82, 1
    s_lshl_b32 s82, s82, 2
    s_load_dword s88, s[14:15], s82
    s_mov_b64 s[44:45], s[34:35]
    s_mov_b32 s46, 9437184
    s_mov_b32 s47, 0x20000
    s_mov_b64 s[52:53], s[30:31]
    s_mov_b32 s54, 2621440
    s_mov_b32 s55, 0x20000
    s_mul_i32 s95, s72, 245760
    s_mul_i32 s89, s72, 81920
    s_add_u32 s89, s89, 1720320
    s_movk_i32 s79, 16384
    s_movk_i32 s80, 5120
    s_movk_i32 s81, 10240
    s_mov_b32 s91, 0xffff0000
    s_mov_b32 s92, 0x5040100
    s_mov_b32 s93, 0x7060302
    s_mov_b64 s[68:69], s[18:19]
    s_mov_b32 s70, 1280
    s_mov_b32 s71, 0x20000
    s_mul_i32 s96, s96, 0x01010101
    s_mov_b32 s97, s96
    s_cmp_lt_u32 s74, 3
    s_cselect_b32 s82, s95, s89
    s_mul_i32 s84, s74, 81920
    s_add_u32 s82, s82, s84
    s_lshl_b32 s84, s101, 7
    s_add_u32 s82, s82, s84
    v_and_b32 v140, 15, v1
    v_lshrrev_b32 v141, 4, v1
    v_lshl_add_u32 v7, v140, 3, s82
    v_lshl_add_u32 v7, v141, 12, v7
    s_mul_i32 s82, s74, 40
    s_add_u32 s82, s82, 89088
    v_xor_b32 v142, 1, v140
    v_mul_u32_u24 v142, 656, v142
    v_add_u32 v142, s82, v142
    v_mul_u32_u24 v143, 160, v141
    v_add_u32 v143, 11152, v143
    v_add_u32 v86, v142, v143
    v_lshrrev_b32 v143, 1, v141
    v_mul_u32_u24 v143, 16, v143
    v_mul_u32_u24 v144, 320, v141
    v_add3_u32 v9, v142, v143, v144
    v_bfe_u32 v142, v1, 2, 2
    s_mul_i32 s82, s74, 160
    s_add_u32 s82, s82, 110848
    v_lshl_add_u32 v87, v142, 3, s82
    v_and_b32 v143, 3, v1
    v_lshl_add_u32 v144, v141, 1, v143
    v_sub_u32 v144, 7, v144
    v_add_u32 v145, -1, v144
    v_add_u32 v143, v143, v141
    v_lshlrev_b32 v142, 2, v1
    v_and_b32 v142, 16, v142
    s_mov_b32 s82, 0x0c0c0c0c
    s_movk_i32 s84, 0x202
    v_mov_b32 v146, 0x0d0c
    v_cmp_gt_u32 s[12:13], 4, v144
    v_cmp_gt_u32 s[14:15], 4, v145
    v_cmp_eq_u32 vcc, 3, v143
    v_mul_u32_u24 v144, s84, v144
    v_mul_u32_u24 v145, s84, v145
    v_xor_b32 v144, v144, v146
    v_xor_b32 v145, v145, v146
    v_mov_b32 v146, 0x3f80
    v_cndmask_b32 v144, 0, v144, s[12:13]
    v_cndmask_b32 v145, 0, v145, s[14:15]
    v_cndmask_b32 v146, 0, v146, vcc
    v_cmp_gt_u32 vcc, 8, v140
    v_lshlrev_b32 v144, v142, v144
    v_lshlrev_b32 v145, v142, v145
    v_lshlrev_b32 v146, v142, v146
    v_xor_b32 v144, s82, v144
    v_xor_b32 v145, s82, v145
    v_mov_b32 v143, s82
    v_cndmask_b32 v76, v143, v144, vcc
    v_cndmask_b32 v77, v144, v143, vcc
    v_cndmask_b32 v78, v143, v145, vcc
    v_cndmask_b32 v79, v145, v143, vcc
    v_mov_b32 v80, 0
    v_mov_b32 v81, 0
    v_mov_b32 v84, 0
    v_mov_b32 v85, 0
    v_cndmask_b32 v82, 0, v146, vcc
    v_cndmask_b32 v83, v146, v80, vcc
    s_lshl_b32 s82, s72, 2
    s_add_u32 s82, s82, s74
    s_lshl_b32 s82, s82, 5
    s_add_u32 s82, s82, s101
    s_lshl_b32 s82, s82, 2
    s_add_u32 s82, s82, 4096
    v_mov_b32 v11, s82
    buffer_load_dwordx4 v[204:207], v8, s[56:59], 0 offen offset:0
    buffer_load_dwordx4 v[208:211], v8, s[56:59], 0 offen offset:1024
    buffer_load_dwordx4 v[212:215], v8, s[56:59], 0 offen offset:2048
    buffer_load_dwordx4 v[216:219], v8, s[56:59], 0 offen offset:3072
    s_mov_b32 m0, s87
    s_mov_b32 exec_hi, 0xff
    buffer_load_dwordx4 v4, s[36:39], 0 offen offset:0 lds
    buffer_load_dwordx4 v4, s[36:39], s76 offen offset:656 lds
    buffer_load_dwordx4 v4, s[36:39], s77 offen offset:1312 lds
    buffer_load_dwordx4 v4, s[36:39], s78 offen offset:1968 lds
    s_add_u32 m0, m0, 10496
    s_mov_b32 exec_hi, -1
    s_cmp_lt_u32 s73, 15
    s_cselect_b32 s82, s95, s89
    s_lshl_b32 s84, s73, 14
    s_add_u32 s82, s82, s84
    s_lshl_b32 s84, s74, 12
    s_add_u32 s82, s82, s84
    v_lshl_add_u32 v63, v1, 7, s82
    v_lshl_add_u32 v252, v1, 4, s82
    s_lshl_b32 s62, s72, 2
    s_mul_i32 s84, s73, 52
    s_lshr_b32 s84, s84, 8
    s_add_u32 s62, s62, s84
    s_lshl_b32 s62, s62, 7
    s_add_u32 s62, s62, 4096
    v_and_b32 v2, 31, v1
    v_lshl_add_u32 v10, v2, 2, s62
    v_min_u32 v74, 11, v1
    v_lshl_add_u32 v74, v74, 2, s62
    s_mul_i32 s82, s74, 8320
    v_lshl_add_u32 v8, v1, 4, s82
    v_mov_b32 v244, 0
    v_mov_b32 v245, 0
    v_mov_b32 v246, 0
    v_mov_b32 v247, 0
    v_mov_b32 v220, 0
    s_mul_i32 s83, s74, 4608
    s_add_u32 s83, s83, 33280
    v_lshl_add_u32 v5, v2, 4, s83
    ds_write_b128 v5, v[244:247]
    s_mov_b64 exec, 3
    ds_write_b128 v8, v[244:247] offset:0
    ds_write_b128 v8, v[244:247] offset:4160
    s_mov_b64 exec, -1
    v_and_b32 v2, 15, v1
    v_lshrrev_b32 v3, 4, v1
    v_lshlrev_b32 v14, 3, v3
    v_sub_u32 v14, v2, v14
    v_add_u32 v14, 25, v14
    v_and_b32 v5, 1, v14
    v_mul_u32_u24 v5, 4162, v5
    v_lshl_add_u32 v5, v14, 1, v5
    v_add_u32_e64 v240, s82, v5
    v_add_u32 v241, 1024, v240
    v_add_u32 v242, 2048, v240
    v_add_u32 v243, 3072, v240
    s_add_u32 s59, s83, 512
    s_add_u32 s83, s83, 32
    v_lshlrev_b32 v248, 5, v2
    v_lshl_add_u32 v248, v3, 4, v248
    v_add_u32 v248, s83, v248
    s_mov_b64 s[48:49], s[4:5]
    s_mov_b32 s50, 2621440
    s_mov_b32 s51, 0x20000
    s_mov_b32 exec_hi, 0xff
    buffer_load_dwordx4 v4, s[40:43], 0 offen offset:0 lds
    buffer_load_dwordx4 v4, s[40:43], s76 offen offset:656 lds
    buffer_load_dwordx4 v4, s[40:43], s77 offen offset:1312 lds
    buffer_load_dwordx4 v4, s[40:43], s78 offen offset:1968 lds
    s_mov_b32 exec_hi, -1
    s_mov_b64 exec, 0xfff
    buffer_load_dword v62, v63, s[52:55], 0 offen sc1
    s_mov_b64 exec, 1
    buffer_load_dword v15, v10, s[44:47], 0 offen sc1
    s_mov_b64 exec, -1
    s_waitcnt vmcnt(10)
    ds_write_b128 v8, v[204:207] offset:32
    v_mov_b32_dpp v220, v207 wave_shr:1 row_mask:0xf bank_mask:0xf
    v_mov_b32_dpp v221, v207 wave_ror:1 row_mask:0xf bank_mask:0xf
    v_alignbyte_b32 v227, v207, v206, 2
    v_alignbyte_b32 v226, v206, v205, 2
    v_alignbyte_b32 v225, v205, v204, 2
    v_alignbyte_b32 v224, v204, v220, 2
    s_lshl_b32 s83, s3, 7
    s_add_u32 s36, s83, 16384
    s_add_u32 s83, s83, 5242880
    v_lshrrev_b32 v6, 3, v0
    v_and_b32 v5, 7, v0
    v_mul_u32_u24 v251, 20480, v6
    ds_write_b128 v8, v[224:227] offset:4192
    v_lshl_add_u32 v251, v5, 4, v251
    v_add_u32 v251, s83, v251
    s_lshl_b32 s82, s74, 10
    v_lshrrev_b32 v5, 2, v2
    v_xor_b32 v5, v5, v3
    v_lshlrev_b32 v249, 5, v2
    v_lshl_add_u32 v249, v5, 3, v249
    v_add_u32 v249, s82, v249
    v_lshrrev_b32 v5, 4, v0
    v_and_b32_e64 v5, 6, v5
    ds_write_b128 v8, v[208:211] offset:1056
    v_mov_b32_dpp v221, v211 wave_shr:1 row_mask:0xf bank_mask:0xf
    v_mov_b32_dpp v222, v211 wave_ror:1 row_mask:0xf bank_mask:0xf
    v_alignbyte_b32 v231, v211, v210, 2
    v_alignbyte_b32 v230, v210, v209, 2
    v_alignbyte_b32 v229, v209, v208, 2
    v_alignbyte_b32 v228, v208, v221, 2
    v_xor_b32 v5, v5, v0
    v_lshlrev_b32 v250, 2, v5
    v_add_u32 v250, 51712, v250
    s_lshr_b32 s82, s73, 1
    s_lshl_b32 s83, s72, 2
    s_add_u32 s82, s82, s83
    ds_write_b128 v8, v[228:231] offset:5216
    s_add_u32 s82, s82, 90
    s_mul_i32 s83, s72, 12
    s_add_u32 s83, s83, s73
    s_and_b32 s37, s73, 1
    s_lshl_b32 s37, s37, 3
    s_cmp_lt_u32 s73, 12
    s_cselect_b32 s82, s83, s82
    s_cselect_b32 s37, 0, s37
    s_cselect_b32 s38, 1, 0
    s_mul_i32 s39, s82, 20480
    ds_write_b128 v8, v[212:215] offset:2080
    v_mov_b32_dpp v222, v215 wave_shr:1 row_mask:0xf bank_mask:0xf
    v_mov_b32_dpp v223, v215 wave_ror:1 row_mask:0xf bank_mask:0xf
    v_alignbyte_b32 v235, v215, v214, 2
    v_alignbyte_b32 v234, v214, v213, 2
    v_alignbyte_b32 v233, v213, v212, 2
    v_alignbyte_b32 v232, v212, v222, 2
    s_add_u32 s56, s39, 5242880
    s_mul_i32 s82, s74, 2560
    s_lshl_b32 s82, s82, s38
    s_mul_i32 s57, s37, 1280
    s_add_u32 s57, s57, s39
    s_add_u32 s57, s57, s82
    ds_write_b128 v8, v[232:235] offset:6240
    s_lshl_b32 s82, 2560, s38
    s_add_u32 s50, s57, s82
    s_mul_i32 s89, s74, 5120
    s_add_u32 s89, s89, 89088
    s_sub_u32 s58, s89, s57
    s_mul_i32 s60, s74, 40
    s_add_u32 s63, s62, 64
    s_add_u32 s62, s62, 48
    v_sub_u32 v14, 16, v14
    v_and_b32_e64 v5, 1, v14
    ds_write_b128 v8, v[216:219] offset:3104
    v_mov_b32_dpp v223, v219 wave_shr:1 row_mask:0xf bank_mask:0xf
    v_alignbyte_b32 v227, v219, v218, 2
    v_alignbyte_b32 v226, v218, v217, 2
    v_alignbyte_b32 v225, v217, v216, 2
    v_alignbyte_b32 v224, v216, v223, 2
    v_lshlrev_b32 v5, 4, v5
    v_ashrrev_i32 v14, 1, v14
    v_mov_b32 v244, -1
    v_mov_b32 v245, -1
    v_mov_b32 v246, -1
    v_mov_b32 v247, -1
    ds_write_b128 v8, v[224:227] offset:7264
    s_movk_i32 s76, 4096
    s_movk_i32 s77, 8192
    s_movk_i32 s78, 12288
    s_mov_b32 m0, s59
    s_waitcnt lgkmcnt(0)
    s_load_dwordx8 s[4:11], s[32:33], s86
    ds_read2_b32 a[32:33], v240 offset0:128 offset1:129
    s_add_u32 s75, s75, 1
    s_and_b32 s94, s75, 0xffff
    ds_read2_b32 a[34:35], v240 offset0:130 offset1:131
    v_mov_b32 v12, s75
    s_bitcmp1_b32 s74, 0
    ds_read2_b32 a[0:1], v240 offset0:0 offset1:1
    s_cselect_b32 s82, 16, 0
    s_lshr_b32 s88, s88, s82
    ds_read2_b32 a[2:3], v240 offset0:2 offset1:3
    s_and_b32 s88, s88, 0xffff
    s_lshl_b32 s61, s88, 16
    ds_read2_b32 a[36:37], v240 offset0:144 offset1:145
    v_lshlrev_b32 v5, v5, s88
    v_cmp_eq_u32 s[12:13], 0, v14
    ds_read2_b32 a[38:39], v240 offset0:146 offset1:147
    v_cmp_eq_u32 s[14:15], 1, v14
    v_cmp_eq_u32 s[16:17], 2, v14
    ds_read2_b32 a[4:5], v240 offset0:16 offset1:17
    v_cmp_eq_u32 vcc, 3, v14
    v_cndmask_b32 v236, 0, v5, s[12:13]
    ds_read2_b32 a[6:7], v240 offset0:18 offset1:19
    v_cndmask_b32 v237, 0, v5, s[14:15]
    v_cndmask_b32 v238, 0, v5, s[16:17]
    ds_read2_b32 a[40:41], v240 offset0:160 offset1:161
    v_cndmask_b32 v239, 0, v5, vcc
    ds_read2_b32 a[42:43], v240 offset0:162 offset1:163
    ds_read2_b32 a[8:9], v240 offset0:32 offset1:33
    ds_read2_b32 a[10:11], v240 offset0:34 offset1:35
    ds_read2_b32 a[44:45], v240 offset0:176 offset1:177
    ds_read2_b32 a[46:47], v240 offset0:178 offset1:179
    ds_read2_b32 a[12:13], v240 offset0:48 offset1:49
    ds_read2_b32 a[14:15], v240 offset0:50 offset1:51
    ds_read2_b32 a[48:49], v240 offset0:192 offset1:193
    ds_read2_b32 a[50:51], v240 offset0:194 offset1:195
    ds_read2_b32 a[16:17], v240 offset0:64 offset1:65
    ds_read2_b32 a[18:19], v240 offset0:66 offset1:67
    ds_read2_b32 a[52:53], v240 offset0:208 offset1:209
    ds_read2_b32 a[54:55], v240 offset0:210 offset1:211
    ds_read2_b32 a[20:21], v240 offset0:80 offset1:81
    ds_read2_b32 a[22:23], v240 offset0:82 offset1:83
    ds_read2_b32 a[56:57], v240 offset0:224 offset1:225
    ds_read2_b32 a[58:59], v240 offset0:226 offset1:227
    ds_read2_b32 a[24:25], v240 offset0:96 offset1:97
    s_mov_b64 exec, 0
    s_cmp_eq_u32 s74, 0
    s_cbranch_scc1 L_padc0
    s_cmp_eq_u32 s74, 1
    s_cbranch_scc1 L_padc1
    s_cmp_eq_u32 s74, 2
    s_cbranch_scc1 L_padc2
    s_branch L_padc3
L_backc:
    s_mov_b64 exec, -1
    s_mov_b32 s90, 131072
    s_waitcnt vmcnt(6) lgkmcnt(0)
    s_barrier
    ds_read_b64 v[64:65], v87 offset:0
    ds_read_b64 v[66:67], v87 offset:32
    ds_read_b64 v[68:69], v87 offset:64
    ds_read_b64 v[70:71], v87 offset:96
    ds_read_b64 v[72:73], v87 offset:128
    ds_read2_b64 v[16:19], v9 offset0:0 offset1:20
    ds_read2_b64 v[20:23], v9 offset0:1 offset1:21
    ds_read2_b64 v[24:27], v9 offset0:2 offset1:22
    ds_read2_b64 v[28:31], v9 offset0:3 offset1:23
    ds_read2_b64 v[32:35], v9 offset0:4 offset1:24
    s_waitcnt lgkmcnt(5)
    v_perm_b32 v36, v65, v64, v76
    v_perm_b32 v37, v65, v64, v77
    v_perm_b32 v38, v65, v64, v78
    v_perm_b32 v39, v65, v64, v79
    v_perm_b32 v40, v67, v66, v76
    v_perm_b32 v41, v67, v66, v77
    v_perm_b32 v42, v67, v66, v78
    v_perm_b32 v43, v67, v66, v79
    v_perm_b32 v44, v69, v68, v76
    v_perm_b32 v45, v69, v68, v77
    v_perm_b32 v46, v69, v68, v78
    v_perm_b32 v47, v69, v68, v79
    v_perm_b32 v48, v71, v70, v76
    v_perm_b32 v49, v71, v70, v77
    v_perm_b32 v50, v71, v70, v78
    v_perm_b32 v51, v71, v70, v79
    v_perm_b32 v52, v73, v72, v76
    v_perm_b32 v53, v73, v72, v77
    v_perm_b32 v54, v73, v72, v78
    v_perm_b32 v55, v73, v72, v79
    s_waitcnt lgkmcnt(0)
    v_mfma_f32_16x16x32_bf16 v[100:103], v[36:39], v[16:19], 0
    ds_read2_b32 a[26:27], v240 offset0:98 offset1:99
    s_xor_b64 s[4:5], s[4:5], s[96:97]
    v_mfma_f32_16x16x32_bf16 v[104:107], v[40:43], v[20:23], 0
    ds_read2_b32 a[60:61], v240 offset0:240 offset1:241
    s_xor_b64 s[6:7], s[6:7], s[96:97]
    v_mfma_f32_16x16x32_bf16 v[108:111], v[44:47], v[24:27], 0
    ds_read2_b32 a[62:63], v240 offset0:242 offset1:243
    s_xor_b64 s[8:9], s[8:9], s[96:97]
    v_mfma_f32_16x16x32_bf16 v[112:115], v[48:51], v[28:31], 0
    ds_read2_b32 a[28:29], v240 offset0:112 offset1:113
    s_xor_b64 s[10:11], s[10:11], s[96:97]
    v_mfma_f32_16x16x32_bf16 v[116:119], v[52:55], v[32:35], 0
    ds_read2_b32 a[30:31], v240 offset0:114 offset1:115
    s_or_b64 s[4:5], s[4:5], s[6:7]
    buffer_load_dword v2, v74, s[44:47], 0 offen sc1
    s_waitcnt vmcnt(3) lgkmcnt(0)
    s_barrier
    ds_read2_b64 v[88:91], v86 offset0:0 offset1:1
    ds_read2_b64 v[92:95], v86 offset0:2 offset1:3
    ds_read2_b64 v[96:99], v86 offset0:4 offset1:4
    s_waitcnt vmcnt(0)
    v_cmp_ne_u32 vcc, s75, v2
    s_cbranch_vccnz L_kv0
L_kv0_ok:
    buffer_load_dwordx4 v252, s[52:55], 0 offen sc1 lds
    s_mov_b32 exec_hi, 0
    buffer_load_dwordx4 v252, s[52:55], 0 offen offset:1024 sc1 lds
    s_mov_b32 exec_hi, -1
    s_waitcnt lgkmcnt(0)
    v_mfma_f32_16x16x32_bf16 v[120:123], v[82:85], v[88:91], 0
    s_or_b64 s[8:9], s[8:9], s[10:11]
    v_mfma_f32_16x16x32_bf16 v[124:127], v[80:83], v[88:91], 0
    s_or_b64 s[4:5], s[4:5], s[8:9]
    v_mfma_f32_16x16x32_bf16 v[128:131], v[82:85], v[92:95], 0
    s_or_b32 s100, s4, s5
    v_mfma_f32_16x16x32_bf16 v[132:135], v[80:83], v[92:95], 0
    s_cselect_b64 s[4:5], 0, 1
    v_mfma_f32_16x16x32_bf16 v[136:139], v[82:85], v[96:99], 0
    s_cmp_eq_u32 s74, 3
    s_nop 3
    s_cselect_b32 s6, -1, 0
    s_mov_b32 s7, 0
    s_mov_b64 s[10:11], 0xfffff
    s_mov_b32 s82, 0
    v_pk_mul_f32 v[100:101], v[100:101], v[120:121]
    v_pk_mul_f32 v[102:103], v[102:103], v[122:123]
    v_cvt_pk_bf16_f32 v190, v100, v101
    v_cvt_pk_bf16_f32 v191, v102, v103
    v_pk_mul_f32 v[104:105], v[104:105], v[124:125]
    v_pk_mul_f32 v[106:107], v[106:107], v[126:127]
    v_cvt_pk_bf16_f32 v192, v104, v105
    v_cvt_pk_bf16_f32 v193, v106, v107
    v_pk_mul_f32 v[108:109], v[108:109], v[128:129]
    v_pk_mul_f32 v[110:111], v[110:111], v[130:131]
    v_cvt_pk_bf16_f32 v194, v108, v109
    v_cvt_pk_bf16_f32 v195, v110, v111
    v_pk_mul_f32 v[112:113], v[112:113], v[132:133]
    v_pk_mul_f32 v[114:115], v[114:115], v[134:135]
    v_cvt_pk_bf16_f32 v196, v112, v113
    v_cvt_pk_bf16_f32 v197, v114, v115
    v_pk_mul_f32 v[116:117], v[116:117], v[136:137]
    v_pk_mul_f32 v[118:119], v[118:119], v[138:139]
    v_cvt_pk_bf16_f32 v198, v116, v117
    v_cvt_pk_bf16_f32 v199, v118, v119
    s_cmp_lg_u32 s100, 0
    s_cbranch_scc1 L_kv_far
L_kv_nearc:
    buffer_store_dwordx2 v[190:191], v7, s[52:55], s82 offen
    s_add_u32 s82, s82, 16384
    buffer_store_dwordx2 v[192:193], v7, s[52:55], s82 offen
    s_add_u32 s82, s82, 16384
    buffer_store_dwordx2 v[194:195], v7, s[52:55], s82 offen
    s_add_u32 s82, s82, 16384
    buffer_store_dwordx2 v[196:197], v7, s[52:55], s82 offen
    s_add_u32 s82, s82, 16384
    buffer_store_dwordx2 v[198:199], v7, s[52:55], s82 offen
L_pre:
    s_mov_b64 exec, -1
    s_barrier
    s_waitcnt vmcnt(5)
    ds_read_b128 v[64:67], v248 offset:448
    ds_read_b128 v[68:71], v248 offset:960
    ds_read_b128 v[72:75], v248 offset:1472
    ds_read_b128 v[76:79], v248 offset:384
    s_mov_b32 s87, 0
    v_bfrev_b32 v61, 1
    ds_read_b128 v[80:83], v248 offset:896
L_padc0:
    s_cbranch_execz L_backc
    s_waitcnt lgkmcnt(4)
    v_mfma_f32_16x16x32_bf16 v[20:23], a[32:35], v[64:67], 0
    ds_read_b128 v[84:87], v248 offset:1408
    v_cndmask_b32 v11, v61, v11, s[4:5]
    v_mfma_f32_16x16x32_bf16 v[16:19], a[0:3], v[64:67], 0
    ds_read_b128 v[88:91], v248 offset:320
    v_cndmask_b32 v63, v61, v63, s[10:11]
    v_mfma_f32_16x16x32_bf16 v[16:19], v[236:239], v[64:67], v[16:19]
    ds_read_b128 v[92:95], v248 offset:832
    s_waitcnt lgkmcnt(6)
    v_mfma_f32_16x16x32_bf16 v[24:27], a[32:35], v[68:71], 0
    ds_read_b128 v[96:99], v248 offset:1344
    v_mfma_f32_16x16x32_bf16 v[20:23], a[0:3], v[68:71], v[20:23]
    ds_read_b128 v[100:103], v248 offset:256
    v_mfma_f32_16x16x32_bf16 v[20:23], v[236:239], v[68:71], v[20:23]
    ds_read2_b32 a[64:65], v241 offset0:0 offset1:1
    s_waitcnt lgkmcnt(8)
    v_mfma_f32_16x16x32_bf16 v[28:31], a[32:35], v[72:75], 0
    ds_read_b128 v[104:107], v248 offset:768
    v_mfma_f32_16x16x32_bf16 v[24:27], a[0:3], v[72:75], v[24:27]
    ds_read2_b32 a[66:67], v241 offset0:2 offset1:3
    v_mfma_f32_16x16x32_bf16 v[24:27], v[236:239], v[72:75], v[24:27]
    ds_read_b128 v[108:111], v248 offset:1280
    s_waitcnt lgkmcnt(10)
    v_mfma_f32_16x16x32_bf16 v[20:23], a[36:39], v[76:79], v[20:23]
    ds_read2_b32 a[68:69], v241 offset0:16 offset1:17
    v_mfma_f32_16x16x32_bf16 v[16:19], a[4:7], v[76:79], v[16:19]
    ds_read_b128 v[112:115], v248 offset:192
    s_waitcnt lgkmcnt(10)
    v_mfma_f32_16x16x32_bf16 v[24:27], a[36:39], v[80:83], v[24:27]
    ds_read2_b32 a[70:71], v241 offset0:18 offset1:19
    v_mfma_f32_16x16x32_bf16 v[20:23], a[4:7], v[80:83], v[20:23]
    ds_read_b128 v[116:119], v248 offset:704
    v_mfma_f32_16x16x32_bf16 v[28:31], a[36:39], v[84:87], v[28:31]
    ds_read2_b32 a[72:73], v241 offset0:32 offset1:33
    v_mfma_f32_16x16x32_bf16 v[24:27], a[4:7], v[84:87], v[24:27]
    ds_read_b128 v[120:123], v248 offset:1216
    s_waitcnt lgkmcnt(10)
    v_mfma_f32_16x16x32_bf16 v[20:23], a[40:43], v[88:91], v[20:23]
    s_waitcnt vmcnt(0)
    buffer_store_dword v12, v11, s[44:47], 0 offen
    v_mfma_f32_16x16x32_bf16 v[16:19], a[8:11], v[88:91], v[16:19]
    ds_read_b128 v[124:127], v248 offset:128
    s_mov_b32 s86, 0
    v_mfma_f32_16x16x32_bf16 v[24:27], a[40:43], v[92:95], v[24:27]
    ds_read2_b32 a[74:75], v241 offset0:34 offset1:35
    buffer_store_dwordx4 v[244:247], v251, s[44:47], s86 offen sc1
    v_mfma_f32_16x16x32_bf16 v[20:23], a[8:11], v[92:95], v[20:23]
    ds_read_b128 v[128:131], v248 offset:640
    v_lshl_add_u32 v11, v1, 2, s36
    v_mfma_f32_16x16x32_bf16 v[28:31], a[40:43], v[96:99], v[28:31]
    ds_read2_b32 a[76:77], v241 offset0:48 offset1:49
    v_cndmask_b32 v11, v61, v11, s[6:7]
    v_mfma_f32_16x16x32_bf16 v[24:27], a[8:11], v[96:99], v[24:27]
    ds_read_b128 v[132:135], v248 offset:1152
    v_lshl_add_u32 v60, v1, 4, s57
    v_mfma_f32_16x16x32_bf16 v[20:23], a[44:47], v[100:103], v[20:23]
    ds_read2_b32 a[78:79], v241 offset0:50 offset1:51
    s_mov_b32 s86, 655360
    v_mfma_f32_16x16x32_bf16 v[16:19], a[12:15], v[100:103], v[16:19]
    ds_read_b128 v[136:139], v248 offset:64
    s_waitcnt lgkmcnt(9)
    v_mfma_f32_16x16x32_bf16 v[24:27], a[44:47], v[104:107], v[24:27]
    ds_read2_b32 a[80:81], v241 offset0:64 offset1:65
    buffer_store_dwordx4 v[244:247], v251, s[44:47], s86 offen sc1
    v_mfma_f32_16x16x32_bf16 v[20:23], a[12:15], v[104:107], v[20:23]
    ds_read_b128 v[140:143], v248 offset:576
    v_lshrrev_b32 v2, 3, v1
    v_mfma_f32_16x16x32_bf16 v[28:31], a[44:47], v[108:111], v[28:31]
    ds_read2_b32 a[82:83], v241 offset0:66 offset1:67
    v_mul_u32_u24 v2, 20352, v2
    v_mfma_f32_16x16x32_bf16 v[24:27], a[12:15], v[108:111], v[24:27]
    ds_read_b128 v[144:147], v248 offset:1088
    s_mov_b32 s86, 1310720
    v_mfma_f32_16x16x32_bf16 v[20:23], a[48:51], v[112:115], v[20:23]
    ds_read2_b32 a[84:85], v241 offset0:80 offset1:81
    buffer_store_dwordx4 v[244:247], v251, s[44:47], s86 offen sc1
    v_mfma_f32_16x16x32_bf16 v[16:19], a[16:19], v[112:115], v[16:19]
    ds_read_b128 v[148:151], v248 offset:0
    v_lshl_add_u32 v2, v1, 4, v2
    v_mfma_f32_16x16x32_bf16 v[24:27], a[48:51], v[116:119], v[24:27]
    ds_read2_b32 a[86:87], v241 offset0:82 offset1:83
    v_add_u32 v2, 638976, v2
    v_mfma_f32_16x16x32_bf16 v[20:23], a[16:19], v[116:119], v[20:23]
    ds_read_b128 v[152:155], v248 offset:512
    s_waitcnt lgkmcnt(10)
    v_mfma_f32_16x16x32_bf16 v[28:31], a[48:51], v[120:123], v[28:31]
    ds_read2_b32 a[88:89], v241 offset0:96 offset1:97
    s_mov_b32 s86, 1966080
    v_mfma_f32_16x16x32_bf16 v[24:27], a[16:19], v[120:123], v[24:27]
    ds_read_b128 v[156:159], v248 offset:1024
    buffer_store_dwordx4 v[244:247], v251, s[44:47], s86 offen sc1
    v_mfma_f32_16x16x32_bf16 v[20:23], a[52:55], v[124:127], v[20:23]
    ds_read2_b32 a[90:91], v241 offset0:98 offset1:99
    v_add_u32 v254, s36, v2
    v_mfma_f32_16x16x32_bf16 v[16:19], a[20:23], v[124:127], v[16:19]
    ds_read2_b32 a[92:93], v241 offset0:112 offset1:113
    v_and_b32_e64 v2, 15, v1
    v_mfma_f32_16x16x32_bf16 v[24:27], a[52:55], v[128:131], v[24:27]
    ds_read2_b32 a[94:95], v241 offset0:114 offset1:115
    v_bfe_u32 v5, v1, 4, 1
    v_mfma_f32_16x16x32_bf16 v[20:23], a[20:23], v[128:131], v[20:23]
    ds_read2_b32 a[96:97], v241 offset0:128 offset1:129
    v_lshl_add_u32 v14, v2, 1, v5
    v_mfma_f32_16x16x32_bf16 v[28:31], a[52:55], v[132:135], v[28:31]
    ds_read2_b32 a[98:99], v241 offset0:130 offset1:131
    buffer_load_dword v62, v63, s[52:55], 0 offen offset:1536 sc1
    v_mfma_f32_16x16x32_bf16 v[24:27], a[20:23], v[132:135], v[24:27]
    ds_read2_b32 a[100:101], v241 offset0:144 offset1:145
    s_waitcnt lgkmcnt(10)
    v_mfma_f32_16x16x32_bf16 v[20:23], a[56:59], v[136:139], v[20:23]
    ds_read2_b32 a[102:103], v241 offset0:146 offset1:147
    v_lshrrev_b32 v13, 5, v0
    v_mfma_f32_16x16x32_bf16 v[16:19], a[24:27], v[136:139], v[16:19]
    ds_read2_b32 a[104:105], v241 offset0:160 offset1:161
    v_lshlrev_b32 v13, s38, v13
    v_mfma_f32_16x16x32_bf16 v[24:27], a[56:59], v[140:143], v[24:27]
    ds_read2_b32 a[106:107], v241 offset0:162 offset1:163
    v_add_u32 v13, s37, v13
    v_mfma_f32_16x16x32_bf16 v[20:23], a[24:27], v[140:143], v[20:23]
    ds_read2_b32 a[108:109], v241 offset0:176 offset1:177
    s_mov_b32 s8, s75
    v_mfma_f32_16x16x32_bf16 v[28:31], a[56:59], v[144:147], v[28:31]
    ds_read2_b32 a[110:111], v241 offset0:178 offset1:179
    s_mov_b32 s9, s75
    v_mfma_f32_16x16x32_bf16 v[24:27], a[24:27], v[144:147], v[24:27]
    ds_read2_b32 a[112:113], v241 offset0:192 offset1:193
    v_mul_u32_u24 v4, 1280, v13
    v_mfma_f32_16x16x32_bf16 v[20:23], a[60:63], v[148:151], v[20:23]
    ds_read2_b32 a[114:115], v241 offset0:194 offset1:195
    v_lshl_add_u32 v4, v14, 3, v4
    v_mfma_f32_16x16x32_bf16 v[16:19], a[28:31], v[148:151], v[16:19]
    ds_read2_b32 a[116:117], v241 offset0:208 offset1:209
    s_waitcnt lgkmcnt(10)
    v_mfma_f32_16x16x32_bf16 v[24:27], a[60:63], v[152:155], v[24:27]
    ds_read2_b32 a[118:119], v241 offset0:210 offset1:211
    v_add_u32 v4, s39, v4
    v_mfma_f32_16x16x32_bf16 v[20:23], a[28:31], v[152:155], v[20:23]
    ds_read2_b32 a[120:121], v241 offset0:224 offset1:225
    v_add_u32 v253, s58, v4
    v_mfma_f32_16x16x32_bf16 v[28:31], a[60:63], v[156:159], v[28:31]
    ds_read2_b32 a[122:123], v241 offset0:226 offset1:227
    v_lshlrev_b32 v6, 7, v14
    v_mfma_f32_16x16x32_bf16 v[24:27], a[28:31], v[156:159], v[24:27]
    ds_read2_b32 a[124:125], v241 offset0:240 offset1:241
    v_lshl_add_u32 v6, v13, 3, v6
    v_mfma_f32_16x16x32_bf16 v[24:27], a[64:67], v[64:67], v[24:27]
    ds_read2_b32 a[126:127], v241 offset0:242 offset1:243
    v_add_u32 v6, s56, v6
    v_mfma_f32_16x16x32_bf16 v[28:31], a[64:67], v[68:71], v[28:31]
    ds_read2_b32 a[128:129], v242 offset0:0 offset1:1
    v_min_u32 v2, 39, v1
    v_mfma_f32_16x16x32_bf16 v[32:35], a[64:67], v[72:75], 0
    ds_read2_b32 a[130:131], v242 offset0:2 offset1:3
    v_add_lshl_u32 v2, v2, s60, 4
    v_mfma_f32_16x16x32_bf16 v[24:27], a[68:71], v[76:79], v[24:27]
    ds_read2_b32 a[132:133], v242 offset0:16 offset1:17
    v_lshlrev_b32_e64 v3, 3, v2
    v_mfma_f32_16x16x32_bf16 v[28:31], a[68:71], v[80:83], v[28:31]
    ds_read2_b32 a[134:135], v242 offset0:18 offset1:19
    v_add_u32 v3, 16384, v3
    v_mfma_f32_16x16x32_bf16 v[32:35], a[68:71], v[84:87], v[32:35]
    ds_read2_b32 a[136:137], v242 offset0:32 offset1:33
    v_add_u32 v7, 139264, v2
    v_mfma_f32_16x16x32_bf16 v[24:27], a[72:75], v[88:91], v[24:27]
    ds_read2_b32 a[138:139], v242 offset0:34 offset1:35
    v_add_u32 v8, 68096, v2
    v_mfma_f32_16x16x32_bf16 v[28:31], a[72:75], v[92:95], v[28:31]
    ds_read2_b32 a[140:141], v242 offset0:48 offset1:49
    v_lshrrev_b32 v15, 1, v2
    v_mfma_f32_16x16x32_bf16 v[32:35], a[72:75], v[96:99], v[32:35]
    ds_read2_b32 a[142:143], v242 offset0:50 offset1:51
    v_lshlrev_b32 v9, 4, v14
    v_mfma_f32_16x16x32_bf16 v[24:27], a[76:79], v[100:103], v[24:27]
    ds_read2_b32 a[144:145], v242 offset0:64 offset1:65
    v_add_u32 v9, 68096, v9
    v_mfma_f32_16x16x32_bf16 v[28:31], a[76:79], v[104:107], v[28:31]
    ds_read2_b32 a[146:147], v242 offset0:66 offset1:67
    v_and_b32 v2, 15, v1
    v_mfma_f32_16x16x32_bf16 v[32:35], a[76:79], v[108:111], v[32:35]
    ds_read2_b32 a[148:149], v242 offset0:80 offset1:81
    v_lshl_add_u32 v201, v2, 5, s59
    v_mfma_f32_16x16x32_bf16 v[24:27], a[80:83], v[112:115], v[24:27]
    ds_read2_b32 a[150:151], v242 offset0:82 offset1:83
    v_lshrrev_b32 v2, 4, v1
    v_mfma_f32_16x16x32_bf16 v[28:31], a[80:83], v[116:119], v[28:31]
    ds_read2_b32 a[152:153], v242 offset0:96 offset1:97
    v_xor_b32_e64 v2, 1, v2
    v_mfma_f32_16x16x32_bf16 v[32:35], a[80:83], v[120:123], v[32:35]
    ds_read2_b32 a[154:155], v242 offset0:98 offset1:99
    v_lshl_add_u32 v201, v2, 3, v201
    v_mfma_f32_16x16x32_bf16 v[24:27], a[84:87], v[124:127], v[24:27]
    ds_read2_b32 a[156:157], v242 offset0:112 offset1:113
    v_mfma_f32_16x16x32_bf16 v[28:31], a[84:87], v[128:131], v[28:31]
    ds_read2_b32 a[158:159], v242 offset0:114 offset1:115
    v_mfma_f32_16x16x32_bf16 v[32:35], a[84:87], v[132:135], v[32:35]
    ds_read2_b32 a[160:161], v242 offset0:128 offset1:129
    v_mfma_f32_16x16x32_bf16 v[24:27], a[88:91], v[136:139], v[24:27]
    ds_read2_b32 a[162:163], v242 offset0:130 offset1:131
    v_mfma_f32_16x16x32_bf16 v[28:31], a[88:91], v[140:143], v[28:31]
    ds_read2_b32 a[164:165], v242 offset0:144 offset1:145
    v_mfma_f32_16x16x32_bf16 v[32:35], a[88:91], v[144:147], v[32:35]
    ds_read2_b32 a[166:167], v242 offset0:146 offset1:147
    v_mfma_f32_16x16x32_bf16 v[24:27], a[92:95], v[148:151], v[24:27]
    ds_read2_b32 a[168:169], v242 offset0:160 offset1:161
    v_mfma_f32_16x16x32_bf16 v[28:31], a[92:95], v[152:155], v[28:31]
    ds_read2_b32 a[170:171], v242 offset0:162 offset1:163
    v_mfma_f32_16x16x32_bf16 v[32:35], a[92:95], v[156:159], v[32:35]
    ds_read2_b32 a[172:173], v242 offset0:176 offset1:177
    s_waitcnt lgkmcnt(10)
    v_mfma_f32_16x16x32_bf16 v[28:31], a[96:99], v[64:67], v[28:31]
    ds_read2_b32 a[174:175], v242 offset0:178 offset1:179
    v_mfma_f32_16x16x32_bf16 v[32:35], a[96:99], v[68:71], v[32:35]
    ds_read2_b32 a[176:177], v242 offset0:192 offset1:193
    v_mfma_f32_16x16x32_bf16 v[36:39], a[96:99], v[72:75], 0
    ds_read2_b32 a[178:179], v242 offset0:194 offset1:195
    v_mfma_f32_16x16x32_bf16 v[28:31], a[100:103], v[76:79], v[28:31]
    ds_read2_b32 a[180:181], v242 offset0:208 offset1:209
    v_mfma_f32_16x16x32_bf16 v[32:35], a[100:103], v[80:83], v[32:35]
    ds_read2_b32 a[182:183], v242 offset0:210 offset1:211
    v_mfma_f32_16x16x32_bf16 v[36:39], a[100:103], v[84:87], v[36:39]
    ds_read2_b32 a[184:185], v242 offset0:224 offset1:225
    v_mfma_f32_16x16x32_bf16 v[28:31], a[104:107], v[88:91], v[28:31]
    ds_read2_b32 a[186:187], v242 offset0:226 offset1:227
    v_mfma_f32_16x16x32_bf16 v[32:35], a[104:107], v[92:95], v[32:35]
    ds_read2_b32 a[188:189], v242 offset0:240 offset1:241
    v_mfma_f32_16x16x32_bf16 v[36:39], a[104:107], v[96:99], v[36:39]
    ds_read2_b32 a[190:191], v242 offset0:242 offset1:243
    v_mfma_f32_16x16x32_bf16 v[28:31], a[108:111], v[100:103], v[28:31]
    ds_read2_b32 a[192:193], v243 offset0:0 offset1:1
    v_mfma_f32_16x16x32_bf16 v[32:35], a[108:111], v[104:107], v[32:35]
    ds_read2_b32 a[194:195], v243 offset0:2 offset1:3
    v_mfma_f32_16x16x32_bf16 v[36:39], a[108:111], v[108:111], v[36:39]
    ds_read2_b32 a[196:197], v243 offset0:16 offset1:17
    v_mfma_f32_16x16x32_bf16 v[28:31], a[112:115], v[112:115], v[28:31]
    ds_read2_b32 a[198:199], v243 offset0:18 offset1:19
    v_mfma_f32_16x16x32_bf16 v[32:35], a[112:115], v[116:119], v[32:35]
    ds_read2_b32 a[200:201], v243 offset0:32 offset1:33
    v_mfma_f32_16x16x32_bf16 v[36:39], a[112:115], v[120:123], v[36:39]
    ds_read2_b32 a[202:203], v243 offset0:34 offset1:35
    v_mfma_f32_16x16x32_bf16 v[28:31], a[116:119], v[124:127], v[28:31]
    ds_read2_b32 a[204:205], v243 offset0:48 offset1:49
    v_mfma_f32_16x16x32_bf16 v[32:35], a[116:119], v[128:131], v[32:35]
    ds_read2_b32 a[206:207], v243 offset0:50 offset1:51
    v_mfma_f32_16x16x32_bf16 v[36:39], a[116:119], v[132:135], v[36:39]
    ds_read2_b32 a[208:209], v243 offset0:64 offset1:65
    v_mfma_f32_16x16x32_bf16 v[28:31], a[120:123], v[136:139], v[28:31]
    ds_read2_b32 a[210:211], v243 offset0:66 offset1:67
    v_mfma_f32_16x16x32_bf16 v[32:35], a[120:123], v[140:143], v[32:35]
    ds_read2_b32 a[212:213], v243 offset0:80 offset1:81
    v_mfma_f32_16x16x32_bf16 v[36:39], a[120:123], v[144:147], v[36:39]
    ds_read2_b32 a[214:215], v243 offset0:82 offset1:83
    v_mfma_f32_16x16x32_bf16 v[28:31], a[124:127], v[148:151], v[28:31]
    s_waitcnt lgkmcnt(9)
    s_load_dwordx4 s[12:15], s[34:35], s62
    s_load_dwordx16 s[16:31], s[34:35], s63
    v_mfma_f32_16x16x32_bf16 v[32:35], a[124:127], v[152:155], v[32:35]
    ds_read2_b32 a[216:217], v243 offset0:96 offset1:97
    v_mfma_f32_16x16x32_bf16 v[36:39], a[124:127], v[156:159], v[36:39]
    ds_read2_b32 a[218:219], v243 offset0:98 offset1:99
    v_mfma_f32_16x16x32_bf16 v[32:35], a[128:131], v[64:67], v[32:35]
    ds_read2_b32 a[220:221], v243 offset0:112 offset1:113
    v_mfma_f32_16x16x32_bf16 v[36:39], a[128:131], v[68:71], v[36:39]
    ds_read2_b32 a[222:223], v243 offset0:114 offset1:115
    v_mfma_f32_16x16x32_bf16 v[40:43], a[128:131], v[72:75], 0
    ds_read2_b32 a[224:225], v243 offset0:128 offset1:129
    v_mfma_f32_16x16x32_bf16 v[32:35], a[132:135], v[76:79], v[32:35]
    ds_read2_b32 a[226:227], v243 offset0:130 offset1:131
    v_mfma_f32_16x16x32_bf16 v[36:39], a[132:135], v[80:83], v[36:39]
    ds_read2_b32 a[228:229], v243 offset0:144 offset1:145
    v_mfma_f32_16x16x32_bf16 v[40:43], a[132:135], v[84:87], v[40:43]
    ds_read2_b32 a[230:231], v243 offset0:146 offset1:147
    v_mfma_f32_16x16x32_bf16 v[32:35], a[136:139], v[88:91], v[32:35]
    ds_read2_b32 a[232:233], v243 offset0:160 offset1:161
    v_mfma_f32_16x16x32_bf16 v[36:39], a[136:139], v[92:95], v[36:39]
    ds_read2_b32 a[234:235], v243 offset0:162 offset1:163
    v_mfma_f32_16x16x32_bf16 v[40:43], a[136:139], v[96:99], v[40:43]
    ds_read2_b32 a[236:237], v243 offset0:176 offset1:177
    v_mfma_f32_16x16x32_bf16 v[32:35], a[140:143], v[100:103], v[32:35]
    ds_read2_b32 a[238:239], v243 offset0:178 offset1:179
    v_mfma_f32_16x16x32_bf16 v[36:39], a[140:143], v[104:107], v[36:39]
    v_mfma_f32_16x16x32_bf16 v[40:43], a[140:143], v[108:111], v[40:43]
    v_mfma_f32_16x16x32_bf16 v[32:35], a[144:147], v[112:115], v[32:35]
    v_mfma_f32_16x16x32_bf16 v[36:39], a[144:147], v[116:119], v[36:39]
    v_mfma_f32_16x16x32_bf16 v[40:43], a[144:147], v[120:123], v[40:43]
    v_mfma_f32_16x16x32_bf16 v[32:35], a[148:151], v[124:127], v[32:35]
    v_mfma_f32_16x16x32_bf16 v[36:39], a[148:151], v[128:131], v[36:39]
    s_waitcnt lgkmcnt(0)
    s_xor_b64 s[12:13], s[12:13], s[8:9]
    v_mfma_f32_16x16x32_bf16 v[40:43], a[148:151], v[132:135], v[40:43]
    s_xor_b64 s[14:15], s[14:15], s[8:9]
    s_or_b64 s[12:13], s[12:13], s[14:15]
    v_mfma_f32_16x16x32_bf16 v[32:35], a[152:155], v[136:139], v[32:35]
    s_xor_b64 s[16:17], s[16:17], s[8:9]
    s_or_b64 s[12:13], s[12:13], s[16:17]
    v_mfma_f32_16x16x32_bf16 v[36:39], a[152:155], v[140:143], v[36:39]
    s_xor_b64 s[18:19], s[18:19], s[8:9]
    s_or_b64 s[12:13], s[12:13], s[18:19]
    v_mfma_f32_16x16x32_bf16 v[40:43], a[152:155], v[144:147], v[40:43]
    s_xor_b64 s[20:21], s[20:21], s[8:9]
    s_or_b64 s[12:13], s[12:13], s[20:21]
    v_mfma_f32_16x16x32_bf16 v[32:35], a[156:159], v[148:151], v[32:35]
    s_xor_b64 s[22:23], s[22:23], s[8:9]
    s_or_b64 s[12:13], s[12:13], s[22:23]
    v_mfma_f32_16x16x32_bf16 v[36:39], a[156:159], v[152:155], v[36:39]
    s_xor_b64 s[24:25], s[24:25], s[8:9]
    s_or_b64 s[12:13], s[12:13], s[24:25]
    v_mfma_f32_16x16x32_bf16 v[40:43], a[156:159], v[156:159], v[40:43]
    s_xor_b64 s[26:27], s[26:27], s[8:9]
    s_or_b64 s[12:13], s[12:13], s[26:27]
    v_mfma_f32_16x16x32_bf16 v[36:39], a[160:163], v[64:67], v[36:39]
    s_xor_b64 s[28:29], s[28:29], s[8:9]
    s_or_b64 s[12:13], s[12:13], s[28:29]
    v_mfma_f32_16x16x32_bf16 v[40:43], a[160:163], v[68:71], v[40:43]
    s_xor_b64 s[30:31], s[30:31], s[8:9]
    v_mfma_f32_16x16x32_bf16 v[44:47], a[160:163], v[72:75], 0
    s_or_b64 s[12:13], s[12:13], s[30:31]
    s_cbranch_scc1 L_kv1
L_kv1_ok:
    v_mfma_f32_16x16x32_bf16 v[36:39], a[164:167], v[76:79], v[36:39]
    buffer_load_dwordx4 v252, s[52:55], 0 offen offset:1024 sc1 lds
    v_mfma_f32_16x16x32_bf16 v[40:43], a[164:167], v[80:83], v[40:43]
    ds_read2_b32 a[240:241], v243 offset0:192 offset1:193
    v_mfma_f32_16x16x32_bf16 v[44:47], a[164:167], v[84:87], v[44:47]
    ds_read2_b32 a[242:243], v243 offset0:194 offset1:195
    v_mfma_f32_16x16x32_bf16 v[36:39], a[168:171], v[88:91], v[36:39]
    ds_read2_b32 a[244:245], v243 offset0:208 offset1:209
    v_mfma_f32_16x16x32_bf16 v[40:43], a[168:171], v[92:95], v[40:43]
    ds_read2_b32 a[246:247], v243 offset0:210 offset1:211
    buffer_load_dwordx4 v252, s[52:55], 0 offen offset:2048 sc1 lds
    v_mfma_f32_16x16x32_bf16 v[44:47], a[168:171], v[96:99], v[44:47]
    ds_read2_b32 a[248:249], v243 offset0:224 offset1:225
    v_mfma_f32_16x16x32_bf16 v[36:39], a[172:175], v[100:103], v[36:39]
    ds_read2_b32 a[250:251], v243 offset0:226 offset1:227
    v_mfma_f32_16x16x32_bf16 v[40:43], a[172:175], v[104:107], v[40:43]
    ds_read2_b32 a[252:253], v243 offset0:240 offset1:241
    v_mfma_f32_16x16x32_bf16 v[44:47], a[172:175], v[108:111], v[44:47]
    ds_read2_b32 a[254:255], v243 offset0:242 offset1:243
    buffer_load_dwordx4 v252, s[52:55], 0 offen offset:3072 sc1 lds
    v_mfma_f32_16x16x32_bf16 v[36:39], a[176:179], v[112:115], v[36:39]
    v_mfma_f32_16x16x32_bf16 v[40:43], a[176:179], v[116:119], v[40:43]
    s_waitcnt vmcnt(4)
    s_barrier
    v_mfma_f32_16x16x32_bf16 v[44:47], a[176:179], v[120:123], v[44:47]
    buffer_store_dword v12, v11, s[44:47], 0 offen sc1
    s_mov_b32 m0, s89
    v_mfma_f32_16x16x32_bf16 v[36:39], a[180:183], v[124:127], v[36:39]
    v_cvt_pk_bf16_f32 v48, v16, v17
    v_cvt_pk_bf16_f32 v49, v18, v19
    v_mfma_f32_16x16x32_bf16 v[40:43], a[180:183], v[128:131], v[40:43]
    ds_write_b64 v249, v[48:49] offset:51712
    buffer_load_dwordx4 v60, s[48:51], 0 offen offset:0 lds
    v_mfma_f32_16x16x32_bf16 v[44:47], a[180:183], v[132:135], v[44:47]
    v_mfma_f32_16x16x32_bf16 v[36:39], a[184:187], v[136:139], v[36:39]
    v_mfma_f32_16x16x32_bf16 v[40:43], a[184:187], v[140:143], v[40:43]
    v_mfma_f32_16x16x32_bf16 v[44:47], a[184:187], v[144:147], v[44:47]
    v_mfma_f32_16x16x32_bf16 v[36:39], a[188:191], v[148:151], v[36:39]
    v_cvt_pk_bf16_f32 v48, v24, v25
    v_cvt_pk_bf16_f32 v49, v26, v27
    v_mfma_f32_16x16x32_bf16 v[40:43], a[188:191], v[152:155], v[40:43]
    ds_write_b64 v249, v[48:49] offset:55808
    buffer_load_dwordx4 v60, s[48:51], 0 offen offset:1024 lds
    v_mfma_f32_16x16x32_bf16 v[44:47], a[188:191], v[156:159], v[44:47]
    v_mfma_f32_16x16x32_bf16 v[40:43], a[192:195], v[64:67], v[40:43]
    v_mfma_f32_16x16x32_bf16 v[44:47], a[192:195], v[68:71], v[44:47]
    v_mfma_f32_16x16x32_bf16 v[40:43], a[196:199], v[76:79], v[40:43]
    buffer_load_dwordx4 v60, s[48:51], 0 offen offset:2048 lds
    v_mfma_f32_16x16x32_bf16 v[44:47], a[196:199], v[80:83], v[44:47]
    v_mfma_f32_16x16x32_bf16 v[40:43], a[200:203], v[88:91], v[40:43]
    v_mfma_f32_16x16x32_bf16 v[44:47], a[200:203], v[92:95], v[44:47]
    v_mfma_f32_16x16x32_bf16 v[40:43], a[204:207], v[100:103], v[40:43]
    v_mfma_f32_16x16x32_bf16 v[44:47], a[204:207], v[104:107], v[44:47]
    buffer_load_dwordx4 v60, s[48:51], 0 offen offset:3072 lds
    v_mfma_f32_16x16x32_bf16 v[40:43], a[208:211], v[112:115], v[40:43]
    v_mfma_f32_16x16x32_bf16 v[44:47], a[208:211], v[116:119], v[44:47]
    v_mfma_f32_16x16x32_bf16 v[40:43], a[212:215], v[124:127], v[40:43]
    s_add_u32 m0, m0, 4096
    v_add_u32 v60, 4096, v60
    v_mfma_f32_16x16x32_bf16 v[44:47], a[212:215], v[128:131], v[44:47]
    v_mfma_f32_16x16x32_bf16 v[40:43], a[216:219], v[136:139], v[40:43]
    s_waitcnt vmcnt(7)
    ds_read_b128 v[160:163], v248 offset:1984
    v_mfma_f32_16x16x32_bf16 v[44:47], a[216:219], v[140:143], v[44:47]
    ds_read_b128 v[164:167], v248 offset:1920
    buffer_load_dwordx4 v60, s[48:51], 0 offen offset:0 lds
    v_mfma_f32_16x16x32_bf16 v[40:43], a[220:223], v[148:151], v[40:43]
    ds_read_b128 v[168:171], v248 offset:1856
    v_cvt_pk_bf16_f32 v50, v20, v21
    v_mfma_f32_16x16x32_bf16 v[44:47], a[220:223], v[152:155], v[44:47]
    ds_read_b128 v[172:175], v248 offset:1792
    v_cvt_pk_bf16_f32 v51, v22, v23
    v_mfma_f32_16x16x32_bf16 v[44:47], a[224:227], v[64:67], v[44:47]
    ds_write_b64 v249, v[50:51] offset:52224
    v_mfma_f32_16x16x32_bf16 v[44:47], a[228:231], v[76:79], v[44:47]
    buffer_load_dwordx2 v[232:233], v15, s[68:71], 0 offen
    v_mfma_f32_16x16x32_bf16 v[44:47], a[232:235], v[88:91], v[44:47]
    ds_read_b128 v[176:179], v248 offset:1728
    v_mfma_f32_16x16x32_bf16 v[44:47], a[236:239], v[100:103], v[44:47]
    ds_read_b128 v[180:183], v248 offset:1664
    s_waitcnt lgkmcnt(7)
    v_mfma_f32_16x16x32_bf16 v[44:47], a[240:243], v[112:115], v[44:47]
    ds_read_b128 v[184:187], v248 offset:1600
    v_mfma_f32_16x16x32_bf16 v[44:47], a[244:247], v[124:127], v[44:47]
    ds_read_b128 v[188:191], v248 offset:1536
    v_mfma_f32_16x16x32_bf16 v[44:47], a[248:251], v[136:139], v[44:47]
    ds_read_b128 v[192:195], v248 offset:1984
    v_mfma_f32_16x16x32_bf16 v[44:47], a[252:255], v[148:151], v[44:47]
    ds_read_b128 v[196:199], v248 offset:1920
    s_waitcnt lgkmcnt(9)
    v_mfma_f32_16x16x32_bf16 v[28:31], a[0:3], v[160:163], v[28:31]
    s_waitcnt vmcnt(7)
    s_waitcnt lgkmcnt(6)
    s_barrier
    v_mfma_f32_16x16x32_bf16 v[28:31], v[236:239], v[160:163], v[28:31]
    ds_read2st64_b32 v[52:53], v250 offset0:0 offset1:4
    v_mfma_f32_16x16x32_bf16 v[28:31], a[4:7], v[164:167], v[28:31]
    ds_read2st64_b32 v[54:55], v250 offset0:8 offset1:12
    v_mfma_f32_16x16x32_bf16 v[28:31], a[8:11], v[168:171], v[28:31]
    ds_read_b128 v[160:163], v248 offset:1856
    v_mfma_f32_16x16x32_bf16 v[28:31], a[12:15], v[172:175], v[28:31]
    ds_read_b128 v[164:167], v248 offset:1792
    s_waitcnt lgkmcnt(9)
    v_mfma_f32_16x16x32_bf16 v[28:31], a[16:19], v[176:179], v[28:31]
    ds_read_b128 v[168:171], v248 offset:1728
    s_waitcnt lgkmcnt(9)
    v_mfma_f32_16x16x32_bf16 v[28:31], a[20:23], v[180:183], v[28:31]
    ds_read_b128 v[172:175], v248 offset:1664
    s_waitcnt lgkmcnt(9)
    v_mfma_f32_16x16x32_bf16 v[28:31], a[24:27], v[184:187], v[28:31]
    ds_read_b128 v[176:179], v248 offset:1600
    s_waitcnt lgkmcnt(9)
    v_mfma_f32_16x16x32_bf16 v[28:31], a[28:31], v[188:191], v[28:31]
    ds_read_b128 v[180:183], v248 offset:1536
    s_waitcnt lgkmcnt(9)
    v_mfma_f32_16x16x32_bf16 v[32:35], a[32:35], v[192:195], v[32:35]
    ds_read_b128 v[184:187], v248 offset:2496
    v_mfma_f32_16x16x32_bf16 v[36:39], a[64:67], v[192:195], v[36:39]
    s_waitcnt lgkmcnt(7)
    v_mfma_f32_16x16x32_bf16 v[32:35], a[36:39], v[196:199], v[32:35]
    ds_read_b128 v[188:191], v248 offset:2432
    v_perm_b32 v56, v53, v52, s92
    v_mfma_f32_16x16x32_bf16 v[36:39], a[68:71], v[196:199], v[36:39]
    v_perm_b32 v57, v55, v54, s92
    s_waitcnt lgkmcnt(7)
    v_mfma_f32_16x16x32_bf16 v[32:35], a[40:43], v[160:163], v[32:35]
    ds_read_b128 v[192:195], v248 offset:2368
    v_perm_b32 v58, v53, v52, s93
    v_mfma_f32_16x16x32_bf16 v[36:39], a[72:75], v[160:163], v[36:39]
    v_perm_b32 v59, v55, v54, s93
    s_waitcnt lgkmcnt(7)
    v_mfma_f32_16x16x32_bf16 v[32:35], a[44:47], v[164:167], v[32:35]
    ds_read_b128 v[196:199], v248 offset:2304
    buffer_store_dwordx4 v[56:59], v251, s[44:47], s87 offen sc1
    v_mfma_f32_16x16x32_bf16 v[36:39], a[76:79], v[164:167], v[36:39]
    s_add_u32 s87, s87, 655360
    s_waitcnt lgkmcnt(6)
    v_mfma_f32_16x16x32_bf16 v[32:35], a[48:51], v[168:171], v[32:35]
    ds_read_b128 v[160:163], v248 offset:2240
    v_cvt_pk_bf16_f32 v50, v28, v29
    v_mfma_f32_16x16x32_bf16 v[36:39], a[80:83], v[168:171], v[36:39]
    v_cvt_pk_bf16_f32 v51, v30, v31
    ds_write_b64 v249, v[50:51] offset:56320
    v_mfma_f32_16x16x32_bf16 v[32:35], a[52:55], v[172:175], v[32:35]
    v_mfma_f32_16x16x32_bf16 v[36:39], a[84:87], v[172:175], v[36:39]
    ds_read_b128 v[164:167], v248 offset:2176
    s_waitcnt lgkmcnt(6)
    v_mfma_f32_16x16x32_bf16 v[32:35], a[56:59], v[176:179], v[32:35]
    ds_read_b128 v[168:171], v248 offset:2112
    v_mfma_f32_16x16x32_bf16 v[36:39], a[88:91], v[176:179], v[36:39]
    v_mfma_f32_16x16x32_bf16 v[32:35], a[60:63], v[180:183], v[32:35]
    ds_read_b128 v[172:175], v248 offset:2048
    v_mfma_f32_16x16x32_bf16 v[36:39], a[92:95], v[180:183], v[36:39]
    v_mfma_f32_16x16x32_bf16 v[32:35], a[0:3], v[184:187], v[32:35]
    ds_read_b128 v[176:179], v248 offset:3008
    v_mfma_f32_16x16x32_bf16 v[36:39], a[32:35], v[184:187], v[36:39]
    s_waitcnt lgkmcnt(4)
    s_barrier
    v_mfma_f32_16x16x32_bf16 v[32:35], v[236:239], v[184:187], v[32:35]
    ds_read2st64_b32 v[52:53], v250 offset0:16 offset1:20
    v_mfma_f32_16x16x32_bf16 v[32:35], a[4:7], v[188:191], v[32:35]
    ds_read2st64_b32 v[54:55], v250 offset0:24 offset1:28
    v_mfma_f32_16x16x32_bf16 v[36:39], a[36:39], v[188:191], v[36:39]
    ds_read_b128 v[180:183], v248 offset:2944
    v_mfma_f32_16x16x32_bf16 v[32:35], a[8:11], v[192:195], v[32:35]
    ds_read_b128 v[184:187], v248 offset:2880
    v_mfma_f32_16x16x32_bf16 v[36:39], a[40:43], v[192:195], v[36:39]
    ds_read_b128 v[188:191], v248 offset:2816
    v_mfma_f32_16x16x32_bf16 v[32:35], a[12:15], v[196:199], v[32:35]
    ds_read_b128 v[192:195], v248 offset:2752
    v_mfma_f32_16x16x32_bf16 v[36:39], a[44:47], v[196:199], v[36:39]
    ds_read_b128 v[196:199], v248 offset:2688
    v_mfma_f32_16x16x32_bf16 v[32:35], a[16:19], v[160:163], v[32:35]
    v_mfma_f32_16x16x32_bf16 v[36:39], a[48:51], v[160:163], v[36:39]
    ds_read_b128 v[160:163], v248 offset:2624
    s_waitcnt lgkmcnt(8)
    v_mfma_f32_16x16x32_bf16 v[32:35], a[20:23], v[164:167], v[32:35]
    s_waitcnt lgkmcnt(6)
    v_perm_b32 v56, v53, v52, s92
    v_mfma_f32_16x16x32_bf16 v[36:39], a[52:55], v[164:167], v[36:39]
    ds_read_b128 v[164:167], v248 offset:2560
    v_perm_b32 v57, v55, v54, s92
    v_mfma_f32_16x16x32_bf16 v[32:35], a[24:27], v[168:171], v[32:35]
    v_perm_b32 v58, v53, v52, s93
    v_perm_b32 v59, v55, v54, s93
    v_mfma_f32_16x16x32_bf16 v[36:39], a[56:59], v[168:171], v[36:39]
    ds_read_b128 v[168:171], v248 offset:1984
    buffer_store_dwordx4 v[56:59], v251, s[44:47], s87 offen sc1
    v_mfma_f32_16x16x32_bf16 v[32:35], a[28:31], v[172:175], v[32:35]
    s_add_u32 s87, s87, 655360
    v_mfma_f32_16x16x32_bf16 v[36:39], a[60:63], v[172:175], v[36:39]
    ds_read_b128 v[172:175], v248 offset:1920
    v_mfma_f32_16x16x32_bf16 v[36:39], a[0:3], v[176:179], v[36:39]
    v_mfma_f32_16x16x32_bf16 v[36:39], v[236:239], v[176:179], v[36:39]
    ds_read_b128 v[176:179], v248 offset:1856
    s_waitcnt lgkmcnt(5)
    v_mfma_f32_16x16x32_bf16 v[36:39], a[4:7], v[180:183], v[36:39]
    ds_read_b128 v[180:183], v248 offset:1792
    v_mfma_f32_16x16x32_bf16 v[36:39], a[8:11], v[184:187], v[36:39]
    ds_read_b128 v[184:187], v248 offset:1728
    v_mfma_f32_16x16x32_bf16 v[36:39], a[12:15], v[188:191], v[36:39]
    ds_read_b128 v[188:191], v248 offset:1664
    v_mfma_f32_16x16x32_bf16 v[36:39], a[16:19], v[192:195], v[36:39]
    ds_read_b128 v[192:195], v248 offset:1600
    v_mfma_f32_16x16x32_bf16 v[36:39], a[20:23], v[196:199], v[36:39]
    ds_read_b128 v[196:199], v248 offset:1536
    s_waitcnt lgkmcnt(8)
    v_mfma_f32_16x16x32_bf16 v[36:39], a[24:27], v[160:163], v[36:39]
    v_cvt_pk_bf16_f32 v48, v32, v33
    v_cvt_pk_bf16_f32 v49, v34, v35
    v_mfma_f32_16x16x32_bf16 v[36:39], a[28:31], v[164:167], v[36:39]
    ds_write_b64 v249, v[48:49] offset:59904
    s_waitcnt lgkmcnt(8)
    v_mfma_f32_16x16x32_bf16 v[40:43], a[96:99], v[168:171], v[40:43]
    v_mfma_f32_16x16x32_bf16 v[44:47], a[128:131], v[168:171], v[44:47]
    ds_read_b128 v[160:163], v248 offset:2496
    s_waitcnt lgkmcnt(8)
    v_mfma_f32_16x16x32_bf16 v[40:43], a[100:103], v[172:175], v[40:43]
    ds_read_b128 v[164:167], v248 offset:2432
    v_mfma_f32_16x16x32_bf16 v[44:47], a[132:135], v[172:175], v[44:47]
    ds_read_b128 v[168:171], v248 offset:2368
    s_waitcnt lgkmcnt(8)
    v_mfma_f32_16x16x32_bf16 v[40:43], a[104:107], v[176:179], v[40:43]
    buffer_load_dword v200, v3, s[44:47], 0 offen sc1
    v_mfma_f32_16x16x32_bf16 v[44:47], a[136:139], v[176:179], v[44:47]
    ds_read_b128 v[172:175], v248 offset:2304
    v_mfma_f32_16x16x32_bf16 v[40:43], a[108:111], v[180:183], v[40:43]
    v_mfma_f32_16x16x32_bf16 v[44:47], a[140:143], v[180:183], v[44:47]
    ds_read_b128 v[176:179], v248 offset:2240
    s_waitcnt lgkmcnt(6)
    v_mfma_f32_16x16x32_bf16 v[40:43], a[112:115], v[184:187], v[40:43]
    v_cvt_pk_bf16_f32 v50, v36, v37
    v_cvt_pk_bf16_f32 v51, v38, v39
L_padc1:
    s_cbranch_execz L_backc
    v_mfma_f32_16x16x32_bf16 v[44:47], a[144:147], v[184:187], v[44:47]
    ds_write_b64 v249, v[50:51] offset:60416
    v_mfma_f32_16x16x32_bf16 v[40:43], a[116:119], v[188:191], v[40:43]
    v_mfma_f32_16x16x32_bf16 v[44:47], a[148:151], v[188:191], v[44:47]
    ds_read_b128 v[180:183], v248 offset:2176
    v_mfma_f32_16x16x32_bf16 v[40:43], a[120:123], v[192:195], v[40:43]
    ds_read_b128 v[184:187], v248 offset:2112
    v_mfma_f32_16x16x32_bf16 v[44:47], a[152:155], v[192:195], v[44:47]
    ds_read_b128 v[188:191], v248 offset:2048
    v_mfma_f32_16x16x32_bf16 v[40:43], a[124:127], v[196:199], v[40:43]
    v_mfma_f32_16x16x32_bf16 v[44:47], a[156:159], v[196:199], v[44:47]
    ds_read_b128 v[192:195], v248 offset:3008
    s_waitcnt lgkmcnt(6)
    v_mfma_f32_16x16x32_bf16 v[40:43], a[64:67], v[160:163], v[40:43]
    v_mfma_f32_16x16x32_bf16 v[44:47], a[96:99], v[160:163], v[44:47]
    ds_read_b128 v[196:199], v248 offset:2944
    v_mfma_f32_16x16x32_bf16 v[40:43], a[68:71], v[164:167], v[40:43]
    s_waitcnt lgkmcnt(5)
    s_barrier
    v_mfma_f32_16x16x32_bf16 v[44:47], a[100:103], v[164:167], v[44:47]
    ds_read2st64_b32 v[52:53], v250 offset0:32 offset1:36
    v_mfma_f32_16x16x32_bf16 v[40:43], a[72:75], v[168:171], v[40:43]
    ds_read2st64_b32 v[54:55], v250 offset0:40 offset1:44
    v_mfma_f32_16x16x32_bf16 v[44:47], a[104:107], v[168:171], v[44:47]
    ds_read_b128 v[160:163], v248 offset:2880
    v_mfma_f32_16x16x32_bf16 v[40:43], a[76:79], v[172:175], v[40:43]
    ds_read_b128 v[164:167], v248 offset:2816
    v_mfma_f32_16x16x32_bf16 v[44:47], a[108:111], v[172:175], v[44:47]
    ds_read_b128 v[168:171], v248 offset:2752
    v_mfma_f32_16x16x32_bf16 v[40:43], a[80:83], v[176:179], v[40:43]
    v_mfma_f32_16x16x32_bf16 v[44:47], a[112:115], v[176:179], v[44:47]
    ds_read_b128 v[172:175], v248 offset:2688
    s_waitcnt lgkmcnt(7)
    v_mfma_f32_16x16x32_bf16 v[40:43], a[84:87], v[180:183], v[40:43]
    v_mfma_f32_16x16x32_bf16 v[44:47], a[116:119], v[180:183], v[44:47]
    ds_read_b128 v[176:179], v248 offset:2624
    s_waitcnt lgkmcnt(5)
    v_mfma_f32_16x16x32_bf16 v[40:43], a[88:91], v[184:187], v[40:43]
    v_perm_b32 v56, v53, v52, s92
    v_perm_b32 v57, v55, v54, s92
    v_mfma_f32_16x16x32_bf16 v[44:47], a[120:123], v[184:187], v[44:47]
    ds_read_b128 v[180:183], v248 offset:2560
    v_perm_b32 v58, v53, v52, s93
    v_mfma_f32_16x16x32_bf16 v[40:43], a[92:95], v[188:191], v[40:43]
    v_perm_b32 v59, v55, v54, s93
    buffer_store_dwordx4 v[56:59], v251, s[44:47], s87 offen sc1
    v_mfma_f32_16x16x32_bf16 v[44:47], a[124:127], v[188:191], v[44:47]
    ds_read_b128 v[184:187], v248 offset:3520
    s_add_u32 s87, s87, 655360
    v_mfma_f32_16x16x32_bf16 v[40:43], a[32:35], v[192:195], v[40:43]
    v_mfma_f32_16x16x32_bf16 v[44:47], a[64:67], v[192:195], v[44:47]
    v_mfma_f32_16x16x32_bf16 v[40:43], a[36:39], v[196:199], v[40:43]
    ds_read_b128 v[188:191], v248 offset:3456
    v_mfma_f32_16x16x32_bf16 v[44:47], a[68:71], v[196:199], v[44:47]
    s_waitcnt lgkmcnt(4)
    v_mfma_f32_16x16x32_bf16 v[40:43], a[40:43], v[160:163], v[40:43]
    ds_read_b128 v[192:195], v248 offset:3392
    v_mfma_f32_16x16x32_bf16 v[44:47], a[72:75], v[160:163], v[44:47]
    v_mfma_f32_16x16x32_bf16 v[40:43], a[44:47], v[164:167], v[40:43]
    ds_read_b128 v[196:199], v248 offset:3328
    v_mfma_f32_16x16x32_bf16 v[44:47], a[76:79], v[164:167], v[44:47]
    v_mfma_f32_16x16x32_bf16 v[40:43], a[48:51], v[168:171], v[40:43]
    ds_read_b128 v[160:163], v248 offset:3264
    v_mfma_f32_16x16x32_bf16 v[44:47], a[80:83], v[168:171], v[44:47]
    v_mfma_f32_16x16x32_bf16 v[40:43], a[52:55], v[172:175], v[40:43]
    ds_read_b128 v[164:167], v248 offset:3200
    v_mfma_f32_16x16x32_bf16 v[44:47], a[84:87], v[172:175], v[44:47]
    s_waitcnt lgkmcnt(5)
    v_mfma_f32_16x16x32_bf16 v[40:43], a[56:59], v[176:179], v[40:43]
    ds_read_b128 v[168:171], v248 offset:3136
    v_mfma_f32_16x16x32_bf16 v[44:47], a[88:91], v[176:179], v[44:47]
    v_mfma_f32_16x16x32_bf16 v[40:43], a[60:63], v[180:183], v[40:43]
    ds_read_b128 v[172:175], v248 offset:3072
    v_mfma_f32_16x16x32_bf16 v[44:47], a[92:95], v[180:183], v[44:47]
    v_mfma_f32_16x16x32_bf16 v[40:43], a[0:3], v[184:187], v[40:43]
    ds_read_b128 v[176:179], v248 offset:4032
    v_mfma_f32_16x16x32_bf16 v[44:47], a[32:35], v[184:187], v[44:47]
    v_mfma_f32_16x16x32_bf16 v[40:43], v[236:239], v[184:187], v[40:43]
    ds_read_b128 v[180:183], v248 offset:3968
    s_waitcnt lgkmcnt(5)
    v_mfma_f32_16x16x32_bf16 v[40:43], a[4:7], v[188:191], v[40:43]
    ds_read_b128 v[184:187], v248 offset:3904
    v_mfma_f32_16x16x32_bf16 v[44:47], a[36:39], v[188:191], v[44:47]
    ds_read_b128 v[188:191], v248 offset:3840
    v_mfma_f32_16x16x32_bf16 v[40:43], a[8:11], v[192:195], v[40:43]
    v_mfma_f32_16x16x32_bf16 v[44:47], a[40:43], v[192:195], v[44:47]
    ds_read_b128 v[192:195], v248 offset:3776
    v_mfma_f32_16x16x32_bf16 v[40:43], a[12:15], v[196:199], v[40:43]
    v_mfma_f32_16x16x32_bf16 v[44:47], a[44:47], v[196:199], v[44:47]
    ds_read_b128 v[196:199], v248 offset:3712
    v_mfma_f32_16x16x32_bf16 v[40:43], a[16:19], v[160:163], v[40:43]
    v_mfma_f32_16x16x32_bf16 v[44:47], a[48:51], v[160:163], v[44:47]
    ds_read_b128 v[160:163], v248 offset:3648
    s_waitcnt lgkmcnt(6)
    v_mfma_f32_16x16x32_bf16 v[40:43], a[20:23], v[164:167], v[40:43]
    v_mfma_f32_16x16x32_bf16 v[44:47], a[52:55], v[164:167], v[44:47]
    ds_read_b128 v[164:167], v248 offset:3584
    v_mfma_f32_16x16x32_bf16 v[40:43], a[24:27], v[168:171], v[40:43]
    v_mfma_f32_16x16x32_bf16 v[44:47], a[56:59], v[168:171], v[44:47]
    v_mfma_f32_16x16x32_bf16 v[40:43], a[28:31], v[172:175], v[40:43]
    v_mfma_f32_16x16x32_bf16 v[44:47], a[60:63], v[172:175], v[44:47]
    v_mfma_f32_16x16x32_bf16 v[44:47], a[0:3], v[176:179], v[44:47]
    v_mfma_f32_16x16x32_bf16 v[44:47], v[236:239], v[176:179], v[44:47]
    s_waitcnt lgkmcnt(2)
    v_mfma_f32_16x16x32_bf16 v[44:47], a[4:7], v[180:183], v[44:47]
    s_waitcnt vmcnt(1)
    v_cmp_ne_u32 vcc, s75, v200
    s_cbranch_vccnz L_fc
L_fc_ok:
    v_mfma_f32_16x16x32_bf16 v[44:47], a[8:11], v[184:187], v[44:47]
    v_mfma_f32_16x16x32_bf16 v[44:47], a[12:15], v[188:191], v[44:47]
    v_mfma_f32_16x16x32_bf16 v[44:47], a[16:19], v[192:195], v[44:47]
    v_mfma_f32_16x16x32_bf16 v[44:47], a[20:23], v[196:199], v[44:47]
    v_cvt_pk_bf16_f32 v48, v40, v41
    s_waitcnt lgkmcnt(0)
    v_mfma_f32_16x16x32_bf16 v[44:47], a[24:27], v[160:163], v[44:47]
    v_cvt_pk_bf16_f32 v49, v42, v43
    ds_write_b64 v249, v[48:49] offset:64000
    v_mfma_f32_16x16x32_bf16 v[44:47], a[28:31], v[164:167], v[44:47]
    s_nop 7
    v_cvt_pk_bf16_f32 v50, v44, v45
    v_cvt_pk_bf16_f32 v51, v46, v47
    ds_write_b64 v249, v[50:51] offset:64512
    s_waitcnt lgkmcnt(0)
    s_barrier
    ds_read2st64_b32 v[52:53], v250 offset0:48 offset1:52
    ds_read2st64_b32 v[54:55], v250 offset0:56 offset1:60
    s_waitcnt lgkmcnt(0)
    v_perm_b32 v56, v53, v52, s92
    v_perm_b32 v57, v55, v54, s92
    v_perm_b32 v58, v53, v52, s93
    v_perm_b32 v59, v55, v54, s93
    buffer_store_dwordx4 v[56:59], v251, s[44:47], s87 offen sc1
    s_cmp_ge_u32 s73, 12
    s_cbranch_scc1 L_ln1
    ds_read_b64 v[16:17], v253 offset:0
    ds_read_b64 v[18:19], v253 offset:256
    ds_read_b64 v[20:21], v253 offset:512
    ds_read_b64 v[22:23], v253 offset:768
    ds_read_b64 v[24:25], v253 offset:1024
    ds_read_b64 v[26:27], v253 offset:1280
    ds_read_b64 v[28:29], v253 offset:1536
    ds_read_b64 v[30:31], v253 offset:1792
    ds_read_b64 v[32:33], v253 offset:2048
    ds_read_b64 v[34:35], v253 offset:2304
    buffer_load_dwordx4 v[208:211], v7, s[44:47], 0 offen offset:0 sc1
    v_lshrrev_b32 v2, 4, v0
    v_xor_b32 v2, v2, v0
    v_and_b32 v2, 7, v2
    v_and_b32 v248, 0xf8, v0
    v_or_b32 v2, v2, v248
    v_lshl_add_u32 v248, v2, 4, s56
    s_lshl_b32 m0, s74, 10
    buffer_load_dwordx4 v[212:215], v7, s[44:47], 0 offen offset:2560 sc1
    v_lshrrev_b32 v2, 1, v13
    v_lshrrev_b32 v249, 1, v14
    v_xor_b32 v2, v2, v249
    v_and_b32 v2, 7, v2
    v_lshlrev_b32_e64 v249, 7, v14
    v_lshl_add_u32 v249, v2, 4, v249
    s_mov_b32 s82, 0x3acccccd
    buffer_load_dwordx4 v[216:219], v7, s[44:47], s80 offen offset:0 sc1
    v_mov_b32 v65, 0x3727c5ac
    v_bfrev_b32 v66, 1
    s_waitcnt lgkmcnt(0)
    v_lshlrev_b32 v88, 16, v16
    v_and_b32 v89, s91, v16
    v_lshlrev_b32 v90, 16, v17
    v_and_b32 v91, s91, v17
    buffer_load_dwordx4 v[220:223], v7, s[44:47], s80 offen offset:2560 sc1
    v_lshlrev_b32 v92, 16, v18
    v_and_b32 v93, s91, v18
    v_lshlrev_b32 v94, 16, v19
    v_and_b32 v95, s91, v19
    v_lshlrev_b32 v96, 16, v20
    v_and_b32 v97, s91, v20
    v_lshlrev_b32 v98, 16, v21
    buffer_load_dwordx4 v[224:227], v7, s[44:47], s81 offen offset:0 sc1
    v_and_b32 v99, s91, v21
    v_lshlrev_b32 v100, 16, v22
    v_and_b32 v101, s91, v22
    v_lshlrev_b32 v102, 16, v23
    v_and_b32 v103, s91, v23
    v_lshlrev_b32 v104, 16, v24
    v_and_b32 v105, s91, v24
    buffer_load_dwordx4 v[228:231], v7, s[44:47], s81 offen offset:2560 sc1
    v_lshlrev_b32 v106, 16, v25
    v_and_b32 v107, s91, v25
    v_lshlrev_b32 v108, 16, v26
    v_and_b32 v109, s91, v26
    v_lshlrev_b32 v110, 16, v27
    v_and_b32 v111, s91, v27
    v_lshlrev_b32 v112, 16, v28
    v_and_b32 v113, s91, v28
    v_lshlrev_b32 v114, 16, v29
    buffer_load_dwordx4 v248, s[44:47], 0 offen sc1 lds
    s_add_u32 m0, m0, 4096
    v_and_b32 v115, s91, v29
    v_lshlrev_b32 v116, 16, v30
    v_and_b32 v117, s91, v30
    v_lshlrev_b32 v118, 16, v31
    v_and_b32 v119, s91, v31
    v_lshlrev_b32 v120, 16, v32
    v_and_b32 v121, s91, v32
    buffer_load_dwordx4 v248, s[44:47], s76 offen sc1 lds
    s_add_u32 m0, m0, 4096
    v_lshlrev_b32 v122, 16, v33
    v_and_b32 v123, s91, v33
    v_lshlrev_b32 v124, 16, v34
    v_and_b32 v125, s91, v34
    v_lshlrev_b32 v126, 16, v35
    v_and_b32 v127, s91, v35
    v_pk_add_f32 v[68:69], v[88:89], v[92:93]
    buffer_load_dwordx4 v248, s[44:47], s77 offen sc1 lds
    s_add_u32 m0, m0, 4096
    v_pk_add_f32 v[70:71], v[90:91], v[94:95]
    v_pk_add_f32 v[72:73], v[108:109], v[112:113]
    v_pk_add_f32 v[74:75], v[110:111], v[114:115]
    v_pk_add_f32 v[68:69], v[68:69], v[96:97]
    v_pk_add_f32 v[70:71], v[70:71], v[98:99]
    v_pk_add_f32 v[72:73], v[72:73], v[116:117]
    v_pk_add_f32 v[74:75], v[74:75], v[118:119]
    buffer_load_dwordx4 v248, s[44:47], s78 offen sc1 lds
    s_add_u32 m0, m0, 4096
    v_pk_add_f32 v[68:69], v[68:69], v[100:101]
    v_pk_add_f32 v[70:71], v[70:71], v[102:103]
    v_pk_add_f32 v[72:73], v[72:73], v[120:121]
    v_pk_add_f32 v[74:75], v[74:75], v[122:123]
    v_pk_add_f32 v[68:69], v[68:69], v[104:105]
    v_pk_add_f32 v[70:71], v[70:71], v[106:107]
    v_pk_add_f32 v[72:73], v[72:73], v[124:125]
    buffer_load_dwordx4 v248, s[44:47], s79 offen sc1 lds
    v_pk_add_f32 v[74:75], v[74:75], v[126:127]
    v_pk_add_f32 v[68:69], v[68:69], v[70:71]
    v_pk_add_f32 v[72:73], v[72:73], v[74:75]
    v_add_f32 v60, v68, v69
    v_add_f32 v61, v72, v73
    v_pk_mul_f32 v[80:81], v[88:89], v[88:89]
    v_pk_mul_f32 v[82:83], v[108:109], v[108:109]
    v_pk_fma_f32 v[80:81], v[90:91], v[90:91], v[80:81]
    v_pk_fma_f32 v[82:83], v[110:111], v[110:111], v[82:83]
    v_pk_fma_f32 v[80:81], v[92:93], v[92:93], v[80:81]
    v_pk_fma_f32 v[82:83], v[112:113], v[112:113], v[82:83]
    v_pk_fma_f32 v[80:81], v[94:95], v[94:95], v[80:81]
    v_pk_fma_f32 v[82:83], v[114:115], v[114:115], v[82:83]
    v_pk_fma_f32 v[80:81], v[96:97], v[96:97], v[80:81]
    v_pk_fma_f32 v[82:83], v[116:117], v[116:117], v[82:83]
    v_pk_fma_f32 v[80:81], v[98:99], v[98:99], v[80:81]
    v_pk_fma_f32 v[82:83], v[118:119], v[118:119], v[82:83]
    v_pk_fma_f32 v[80:81], v[100:101], v[100:101], v[80:81]
    v_pk_fma_f32 v[82:83], v[120:121], v[120:121], v[82:83]
    v_pk_fma_f32 v[80:81], v[102:103], v[102:103], v[80:81]
    v_pk_fma_f32 v[82:83], v[122:123], v[122:123], v[82:83]
    v_pk_fma_f32 v[80:81], v[104:105], v[104:105], v[80:81]
    v_pk_fma_f32 v[82:83], v[124:125], v[124:125], v[82:83]
    v_pk_fma_f32 v[80:81], v[106:107], v[106:107], v[80:81]
    v_pk_fma_f32 v[82:83], v[126:127], v[126:127], v[82:83]
    v_add_f32 v56, v80, v81
    v_add_f32 v58, v82, v83
    s_nop 0
    v_permlane16_swap_b32 v60, v61
    v_permlane16_swap_b32 v56, v58
    v_add_f32 v60, v60, v61
    v_add_f32 v56, v56, v58
    s_nop 0
    v_add_f32_dpp v60, v60, v60 row_ror:8 row_mask:0xf bank_mask:0xf
    v_add_f32_dpp v56, v56, v56 row_ror:8 row_mask:0xf bank_mask:0xf
    s_nop 0
    v_add_f32_dpp v60, v60, v60 row_ror:4 row_mask:0xf bank_mask:0xf
    v_add_f32_dpp v56, v56, v56 row_ror:4 row_mask:0xf bank_mask:0xf
    s_nop 0
    v_add_f32_dpp v60, v60, v60 row_ror:2 row_mask:0xf bank_mask:0xf
    v_add_f32_dpp v56, v56, v56 row_ror:2 row_mask:0xf bank_mask:0xf
    s_nop 0
    v_add_f32_dpp v60, v60, v60 row_ror:1 row_mask:0xf bank_mask:0xf
    v_add_f32_dpp v56, v56, v56 row_ror:1 row_mask:0xf bank_mask:0xf
    v_mul_f32 v60, s82, v60
    v_fma_f32 v56, v56, s82, v65
    v_fma_f32 v56, -v60, v60, v56
    v_max_f32 v56, v65, v56
    v_rsq_f32 v56, v56
    s_lshl_b32 s83, s3, 4
    v_add_u32 v11, s83, v13
    v_mul_f32 v57, -v60, v56
    v_mov_b32 v58, v56
    v_mov_b32 v59, v57
    v_add_u32_e64 v10, v11, v5
    v_permlane16_swap_b32 v56, v58
    v_permlane16_swap_b32 v57, v59
    v_pk_fma_f32 v[128:129], v[88:89], v[56:57], v[56:57] op_sel:[0,0,1] op_sel_hi:[1,0,1]
    v_pk_fma_f32 v[148:149], v[108:109], v[58:59], v[58:59] op_sel:[0,0,1] op_sel_hi:[1,0,1]
    v_pk_fma_f32 v[130:131], v[90:91], v[56:57], v[56:57] op_sel:[0,0,1] op_sel_hi:[1,0,1]
    v_pk_fma_f32 v[150:151], v[110:111], v[58:59], v[58:59] op_sel:[0,0,1] op_sel_hi:[1,0,1]
    v_pk_fma_f32 v[132:133], v[92:93], v[56:57], v[56:57] op_sel:[0,0,1] op_sel_hi:[1,0,1]
    v_pk_fma_f32 v[152:153], v[112:113], v[58:59], v[58:59] op_sel:[0,0,1] op_sel_hi:[1,0,1]
    v_pk_fma_f32 v[134:135], v[94:95], v[56:57], v[56:57] op_sel:[0,0,1] op_sel_hi:[1,0,1]
    v_pk_fma_f32 v[154:155], v[114:115], v[58:59], v[58:59] op_sel:[0,0,1] op_sel_hi:[1,0,1]
    v_pk_fma_f32 v[136:137], v[96:97], v[56:57], v[56:57] op_sel:[0,0,1] op_sel_hi:[1,0,1]
    v_pk_fma_f32 v[156:157], v[116:117], v[58:59], v[58:59] op_sel:[0,0,1] op_sel_hi:[1,0,1]
    v_pk_fma_f32 v[138:139], v[98:99], v[56:57], v[56:57] op_sel:[0,0,1] op_sel_hi:[1,0,1]
    v_pk_fma_f32 v[158:159], v[118:119], v[58:59], v[58:59] op_sel:[0,0,1] op_sel_hi:[1,0,1]
    v_pk_fma_f32 v[140:141], v[100:101], v[56:57], v[56:57] op_sel:[0,0,1] op_sel_hi:[1,0,1]
    v_pk_fma_f32 v[160:161], v[120:121], v[58:59], v[58:59] op_sel:[0,0,1] op_sel_hi:[1,0,1]
    v_pk_fma_f32 v[142:143], v[102:103], v[56:57], v[56:57] op_sel:[0,0,1] op_sel_hi:[1,0,1]
    v_pk_fma_f32 v[162:163], v[122:123], v[58:59], v[58:59] op_sel:[0,0,1] op_sel_hi:[1,0,1]
    v_pk_fma_f32 v[144:145], v[104:105], v[56:57], v[56:57] op_sel:[0,0,1] op_sel_hi:[1,0,1]
    v_pk_fma_f32 v[164:165], v[124:125], v[58:59], v[58:59] op_sel:[0,0,1] op_sel_hi:[1,0,1]
    v_pk_fma_f32 v[146:147], v[106:107], v[56:57], v[56:57] op_sel:[0,0,1] op_sel_hi:[1,0,1]
    v_pk_fma_f32 v[166:167], v[126:127], v[58:59], v[58:59] op_sel:[0,0,1] op_sel_hi:[1,0,1]
    s_mul_i32 s83, s3, 2560
    v_and_b32 v2, 31, v1
    v_lshl_add_u32 v3, v2, 4, s83
    v_mov_b32 v252, 88576
    v_mov_b32 v2, 0
    ds_write_b32 v252, v2
    s_mov_b32 s14, 65537
    s_mov_b32 s15, 65537
    s_movk_i32 s83, 0xf000
    v_lshlrev_b32 v204, 16, v232
    v_and_b32 v205, s91, v232
    v_lshlrev_b32 v206, 16, v233
    v_and_b32 v207, s91, v233
    s_mov_b32 s90, 131072
    s_waitcnt vmcnt(5)
L_modchk2:
    v_xor_b32_e64 v2, s94, v208
    v_bitop3_b32 v2, v2, v213, s94 bitop3:0xf6
    v_bitop3_b32 v2, v2, v218, s94 bitop3:0xf6
    v_bitop3_b32 v2, v2, v223, s94 bitop3:0xf6
    v_bitop3_b32 v2, v2, v224, s94 bitop3:0xf6
    v_bitop3_b32 v2, v2, v229, s94 bitop3:0xf6
    v_and_b32 v2, 0xffff, v2
    v_cmp_ne_u32 vcc, 0, v2
    s_cbranch_vccnz L_modre2
L_modok2:
    v_and_b32 v212, s91, v212
    v_and_b32 v213, s91, v213
    v_and_b32 v214, s91, v214
    v_and_b32 v215, s91, v215
    v_and_b32 v216, s91, v216
    v_and_b32 v217, s91, v217
    v_and_b32 v218, s91, v218
    v_and_b32 v219, s91, v219
    v_pk_fma_f32 v[212:213], v[212:213], v[216:217], v[216:217]
    v_pk_fma_f32 v[214:215], v[214:215], v[218:219], v[218:219]
    ds_write_b128 v8, v[212:215] offset:0
    v_and_b32 v208, s91, v208
    v_and_b32 v209, s91, v209
    v_and_b32 v210, s91, v210
    v_and_b32 v211, s91, v211
    v_pk_mul_f32 v[208:209], v[208:209], v[216:217]
    v_pk_mul_f32 v[210:211], v[210:211], v[218:219]
    ds_write_b128 v8, v[208:211] offset:2560
    v_and_b32 v224, s91, v224
    v_and_b32 v225, s91, v225
    v_and_b32 v226, s91, v226
    v_and_b32 v227, s91, v227
    v_pk_add_f32 v[224:225], v[224:225], 1.0 op_sel_hi:[1,0]
    v_pk_add_f32 v[226:227], v[226:227], 1.0 op_sel_hi:[1,0]
    v_pk_mul_f32 v[204:205], v[204:205], v[224:225]
    v_pk_mul_f32 v[206:207], v[206:207], v[226:227]
    ds_write_b128 v8, v[204:207] offset:5120
    s_mov_b32 s90, 131072
    s_waitcnt vmcnt(0) lgkmcnt(0)
    s_barrier
    ds_read_b128 v[36:39], v249 offset:0
    ds_read_b128 v[40:43], v249 offset:4096
    ds_read_b128 v[44:47], v249 offset:8192
    ds_read_b128 v[48:51], v249 offset:12288
    ds_read_b128 v[52:55], v249 offset:16384
    ds_read_b128 v[168:171], v9 offset:0
    ds_read_b128 v[188:191], v9 offset:2560
    ds_read_b128 v[172:175], v9 offset:512
    ds_read_b128 v[192:195], v9 offset:3072
    v_and_b32 v220, s91, v220
    v_and_b32 v221, s91, v221
    v_and_b32 v222, s91, v222
    v_and_b32 v223, s91, v223
    v_and_b32 v228, s91, v228
    v_and_b32 v229, s91, v229
    v_and_b32 v230, s91, v230
    v_and_b32 v231, s91, v231
    s_waitcnt lgkmcnt(4)
L_ychk2:
    v_max3_u32 v2, v36, v40, v44
    v_max3_u32 v2, v2, v48, v52
    v_cmp_eq_u32 vcc, -1, v2
    s_cbranch_vccnz L_yre2
L_yok2:
    ds_read_b128 v[176:179], v9 offset:1024
    v_lshlrev_b32 v16, 16, v36
    v_and_b32 v17, s91, v36
    v_lshlrev_b32 v18, 16, v37
    ds_read_b128 v[196:199], v9 offset:3584
    v_and_b32 v19, s91, v37
    v_lshlrev_b32 v20, 16, v38
    v_and_b32 v21, s91, v38
    ds_read_b128 v[180:183], v9 offset:1536
    v_lshlrev_b32 v22, 16, v39
    v_and_b32 v23, s91, v39
    v_lshlrev_b32 v24, 16, v40
    ds_read_b128 v[200:203], v9 offset:4096
    v_and_b32 v25, s91, v40
    v_lshlrev_b32 v26, 16, v41
    v_and_b32 v27, s91, v41
    ds_read_b128 v[184:187], v9 offset:2048
    v_lshlrev_b32 v28, 16, v42
    v_and_b32 v29, s91, v42
    v_lshlrev_b32 v30, 16, v43
    ds_read_b128 v[204:207], v9 offset:4608
    v_and_b32 v31, s91, v43
    v_lshlrev_b32 v32, 16, v44
    v_and_b32 v33, s91, v44
    v_lshlrev_b32 v34, 16, v45
    v_and_b32 v35, s91, v45
    v_lshlrev_b32 v232, 16, v46
    v_and_b32 v233, s91, v46
    v_lshlrev_b32 v234, 16, v47
    v_and_b32 v235, s91, v47
    v_lshlrev_b32 v236, 16, v48
    v_and_b32 v237, s91, v48
    v_lshlrev_b32 v238, 16, v49
    v_and_b32 v239, s91, v49
    v_lshlrev_b32 v240, 16, v50
    v_and_b32 v241, s91, v50
    v_lshlrev_b32 v242, 16, v51
    v_and_b32 v243, s91, v51
    v_lshlrev_b32 v244, 16, v52
    v_and_b32 v245, s91, v52
    v_lshlrev_b32 v246, 16, v53
    v_and_b32 v247, s91, v53
    v_lshlrev_b32 v208, 16, v54
    v_and_b32 v209, s91, v54
    v_lshlrev_b32 v210, 16, v55
    v_and_b32 v211, s91, v55
    s_waitcnt lgkmcnt(0)
    v_pk_fma_f32 v[128:129], v[128:129], v[168:169], v[188:189]
    v_pk_fma_f32 v[148:149], v[148:149], v[168:169], v[188:189]
    v_pk_fma_f32 v[130:131], v[130:131], v[170:171], v[190:191]
    v_pk_fma_f32 v[150:151], v[150:151], v[170:171], v[190:191]
    v_pk_fma_f32 v[132:133], v[132:133], v[172:173], v[192:193]
    v_pk_fma_f32 v[152:153], v[152:153], v[172:173], v[192:193]
    v_pk_fma_f32 v[134:135], v[134:135], v[174:175], v[194:195]
    v_pk_fma_f32 v[154:155], v[154:155], v[174:175], v[194:195]
    v_pk_fma_f32 v[136:137], v[136:137], v[176:177], v[196:197]
    v_pk_fma_f32 v[156:157], v[156:157], v[176:177], v[196:197]
    v_pk_fma_f32 v[138:139], v[138:139], v[178:179], v[198:199]
    v_pk_fma_f32 v[158:159], v[158:159], v[178:179], v[198:199]
    v_pk_fma_f32 v[140:141], v[140:141], v[180:181], v[200:201]
    v_pk_fma_f32 v[160:161], v[160:161], v[180:181], v[200:201]
    v_pk_fma_f32 v[142:143], v[142:143], v[182:183], v[202:203]
    v_pk_fma_f32 v[162:163], v[162:163], v[182:183], v[202:203]
    v_pk_fma_f32 v[144:145], v[144:145], v[184:185], v[204:205]
    v_pk_fma_f32 v[164:165], v[164:165], v[184:185], v[204:205]
    v_pk_fma_f32 v[146:147], v[146:147], v[186:187], v[206:207]
    v_pk_fma_f32 v[166:167], v[166:167], v[186:187], v[206:207]
    ds_read_b128 v[168:171], v9 offset:5120
    v_pk_fma_f32 v[128:129], v[128:129], v[16:17], v[88:89]
    v_pk_fma_f32 v[130:131], v[130:131], v[18:19], v[90:91]
    ds_read_b128 v[172:175], v9 offset:5632
    v_pk_fma_f32 v[148:149], v[148:149], v[20:21], v[108:109]
    v_pk_fma_f32 v[150:151], v[150:151], v[22:23], v[110:111]
    ds_read_b128 v[176:179], v9 offset:6144
    v_pk_fma_f32 v[132:133], v[132:133], v[24:25], v[92:93]
    v_pk_fma_f32 v[134:135], v[134:135], v[26:27], v[94:95]
    ds_read_b128 v[180:183], v9 offset:6656
    v_pk_fma_f32 v[152:153], v[152:153], v[28:29], v[112:113]
    v_pk_fma_f32 v[154:155], v[154:155], v[30:31], v[114:115]
    ds_read_b128 v[184:187], v9 offset:7168
    v_pk_fma_f32 v[136:137], v[136:137], v[32:33], v[96:97]
    v_pk_fma_f32 v[138:139], v[138:139], v[34:35], v[98:99]
    v_pk_fma_f32 v[156:157], v[156:157], v[232:233], v[116:117]
    v_pk_fma_f32 v[158:159], v[158:159], v[234:235], v[118:119]
    v_pk_fma_f32 v[140:141], v[140:141], v[236:237], v[100:101]
    v_pk_fma_f32 v[142:143], v[142:143], v[238:239], v[102:103]
    v_pk_fma_f32 v[160:161], v[160:161], v[240:241], v[120:121]
    v_pk_fma_f32 v[162:163], v[162:163], v[242:243], v[122:123]
    v_pk_fma_f32 v[144:145], v[144:145], v[244:245], v[104:105]
    v_pk_fma_f32 v[146:147], v[146:147], v[246:247], v[106:107]
    v_pk_fma_f32 v[164:165], v[164:165], v[208:209], v[124:125]
    ds_write_b128 v8, v[224:227] offset:7680
    v_pk_fma_f32 v[166:167], v[166:167], v[210:211], v[126:127]
    v_pk_add_f32 v[68:69], v[128:129], v[132:133]
    v_pk_add_f32 v[70:71], v[130:131], v[134:135]
    v_pk_add_f32 v[72:73], v[148:149], v[152:153]
    v_pk_add_f32 v[74:75], v[150:151], v[154:155]
    v_pk_add_f32 v[68:69], v[68:69], v[136:137]
    v_pk_add_f32 v[70:71], v[70:71], v[138:139]
    v_pk_add_f32 v[72:73], v[72:73], v[156:157]
    v_pk_add_f32 v[74:75], v[74:75], v[158:159]
    v_pk_add_f32 v[68:69], v[68:69], v[140:141]
    v_pk_add_f32 v[70:71], v[70:71], v[142:143]
    v_pk_add_f32 v[72:73], v[72:73], v[160:161]
    v_pk_add_f32 v[74:75], v[74:75], v[162:163]
    v_pk_add_f32 v[68:69], v[68:69], v[144:145]
    v_pk_add_f32 v[70:71], v[70:71], v[146:147]
    v_pk_add_f32 v[72:73], v[72:73], v[164:165]
    v_pk_add_f32 v[74:75], v[74:75], v[166:167]
    v_pk_add_f32 v[68:69], v[68:69], v[70:71]
    v_pk_add_f32 v[72:73], v[72:73], v[74:75]
    v_add_f32 v60, v68, v69
    v_add_f32_e64 v61, v72, v73
    s_waitcnt lgkmcnt(1)
    ds_write_b128 v8, v[220:223] offset:10240
    v_pk_add_f32 v[76:77], v[168:169], v[172:173]
    v_pk_add_f32 v[78:79], v[170:171], v[174:175]
    v_pk_add_f32 v[76:77], v[76:77], v[176:177]
    v_pk_add_f32 v[78:79], v[78:79], v[178:179]
    v_pk_add_f32 v[76:77], v[76:77], v[180:181]
    v_pk_add_f32 v[78:79], v[78:79], v[182:183]
    v_pk_add_f32 v[76:77], v[76:77], v[184:185]
    v_pk_add_f32 v[78:79], v[78:79], v[186:187]
    v_pk_add_f32 v[76:77], v[76:77], v[78:79]
    v_add_f32 v64, v76, v77
    ds_write_b128 v8, v[228:231] offset:12800
    v_mov_b32 v68, v64
    v_pk_mul_f32 v[80:81], v[128:129], v[128:129]
    v_pk_mul_f32 v[82:83], v[148:149], v[148:149]
    v_pk_mul_f32 v[84:85], v[128:129], v[168:169]
    v_pk_mul_f32 v[86:87], v[148:149], v[168:169]
    v_pk_fma_f32 v[80:81], v[130:131], v[130:131], v[80:81]
    v_pk_fma_f32 v[82:83], v[150:151], v[150:151], v[82:83]
    v_pk_fma_f32 v[84:85], v[130:131], v[170:171], v[84:85]
    v_pk_fma_f32 v[86:87], v[150:151], v[170:171], v[86:87]
    v_pk_fma_f32 v[80:81], v[132:133], v[132:133], v[80:81]
    v_pk_fma_f32 v[82:83], v[152:153], v[152:153], v[82:83]
    v_pk_fma_f32 v[84:85], v[132:133], v[172:173], v[84:85]
    v_pk_fma_f32 v[86:87], v[152:153], v[172:173], v[86:87]
    v_pk_fma_f32 v[80:81], v[134:135], v[134:135], v[80:81]
    v_pk_fma_f32 v[82:83], v[154:155], v[154:155], v[82:83]
    v_pk_fma_f32 v[84:85], v[134:135], v[174:175], v[84:85]
    v_pk_fma_f32 v[86:87], v[154:155], v[174:175], v[86:87]
    v_pk_fma_f32 v[80:81], v[136:137], v[136:137], v[80:81]
    v_pk_fma_f32 v[82:83], v[156:157], v[156:157], v[82:83]
    v_pk_fma_f32 v[84:85], v[136:137], v[176:177], v[84:85]
    v_pk_fma_f32 v[86:87], v[156:157], v[176:177], v[86:87]
    v_pk_fma_f32 v[80:81], v[138:139], v[138:139], v[80:81]
    v_pk_fma_f32 v[82:83], v[158:159], v[158:159], v[82:83]
    v_pk_fma_f32 v[84:85], v[138:139], v[178:179], v[84:85]
    v_pk_fma_f32 v[86:87], v[158:159], v[178:179], v[86:87]
    v_pk_fma_f32 v[80:81], v[140:141], v[140:141], v[80:81]
    v_pk_fma_f32 v[82:83], v[160:161], v[160:161], v[82:83]
    v_pk_fma_f32 v[84:85], v[140:141], v[180:181], v[84:85]
    v_pk_fma_f32 v[86:87], v[160:161], v[180:181], v[86:87]
    v_pk_fma_f32 v[80:81], v[142:143], v[142:143], v[80:81]
    v_pk_fma_f32 v[82:83], v[162:163], v[162:163], v[82:83]
    v_pk_fma_f32 v[84:85], v[142:143], v[182:183], v[84:85]
    v_pk_fma_f32 v[86:87], v[162:163], v[182:183], v[86:87]
    v_pk_fma_f32 v[80:81], v[144:145], v[144:145], v[80:81]
    v_pk_fma_f32 v[82:83], v[164:165], v[164:165], v[82:83]
    v_pk_fma_f32 v[84:85], v[144:145], v[184:185], v[84:85]
    v_pk_fma_f32 v[86:87], v[164:165], v[184:185], v[86:87]
    v_pk_fma_f32 v[80:81], v[146:147], v[146:147], v[80:81]
    v_pk_fma_f32 v[82:83], v[166:167], v[166:167], v[82:83]
    v_pk_fma_f32 v[84:85], v[146:147], v[186:187], v[84:85]
    v_pk_fma_f32 v[86:87], v[166:167], v[186:187], v[86:87]
    v_add_f32 v56, v80, v81
    v_add_f32 v58, v82, v83
    v_add_f32 v62, v84, v85
    v_add_f32 v63, v86, v87
    v_permlane16_swap_b32 v60, v61
    v_permlane16_swap_b32 v64, v68
    v_permlane16_swap_b32 v56, v58
    v_permlane16_swap_b32 v62, v63
    v_add_f32 v60, v60, v61
    v_add_f32 v64, v64, v68
    v_add_f32 v56, v56, v58
    v_add_f32 v62, v62, v63
    v_add_f32_dpp v60, v60, v60 row_ror:8 row_mask:0xf bank_mask:0xf
    v_add_f32_dpp v64, v64, v64 row_ror:8 row_mask:0xf bank_mask:0xf
    v_add_f32_dpp v56, v56, v56 row_ror:8 row_mask:0xf bank_mask:0xf
    v_add_f32_dpp v62, v62, v62 row_ror:8 row_mask:0xf bank_mask:0xf
    v_add_f32_dpp v60, v60, v60 row_ror:4 row_mask:0xf bank_mask:0xf
    v_add_f32_dpp v64, v64, v64 row_ror:4 row_mask:0xf bank_mask:0xf
    v_add_f32_dpp v56, v56, v56 row_ror:4 row_mask:0xf bank_mask:0xf
    v_add_f32_dpp v62, v62, v62 row_ror:4 row_mask:0xf bank_mask:0xf
    v_add_f32_dpp v60, v60, v60 row_ror:2 row_mask:0xf bank_mask:0xf
    v_add_f32_dpp v64, v64, v64 row_ror:2 row_mask:0xf bank_mask:0xf
    v_add_f32_dpp v56, v56, v56 row_ror:2 row_mask:0xf bank_mask:0xf
    v_add_f32_dpp v62, v62, v62 row_ror:2 row_mask:0xf bank_mask:0xf
    v_add_f32_dpp v60, v60, v60 row_ror:1 row_mask:0xf bank_mask:0xf
    v_add_f32_dpp v64, v64, v64 row_ror:1 row_mask:0xf bank_mask:0xf
    v_add_f32_dpp v56, v56, v56 row_ror:1 row_mask:0xf bank_mask:0xf
    v_add_f32_dpp v62, v62, v62 row_ror:1 row_mask:0xf bank_mask:0xf
    v_mul_f32 v60, s82, v60
    v_fma_f32 v56, v56, s82, v65
    v_fma_f32 v56, -v60, v60, v56
    v_max_f32 v56, v65, v56
    v_rsq_f32 v56, v56
    v_fma_f32 v62, -v60, v64, v62
    v_mul_f32 v62, v62, v56
    v_ashrrev_i32 v68, 31, v62
    v_bitop3_b32 v68, v68, v66, v62 bitop3:0x56
    v_and_or_b32 v10, v68, s83, v10
    s_mov_b64 exec, s[14:15]
    ds_max_u32 v252, v10
    s_mov_b64 exec, -1
    v_mul_f32 v57, -v60, v56
    v_mov_b32 v58, v56
    v_mov_b32 v59, v57
    v_mov_b32 v251, s75
    v_permlane16_swap_b32 v56, v58
    v_permlane16_swap_b32 v57, v59
    v_pk_fma_f32 v[88:89], v[128:129], v[56:57], v[56:57] op_sel:[0,0,1] op_sel_hi:[1,0,1]
    v_pk_fma_f32 v[108:109], v[148:149], v[58:59], v[58:59] op_sel:[0,0,1] op_sel_hi:[1,0,1]
    v_pk_fma_f32 v[90:91], v[130:131], v[56:57], v[56:57] op_sel:[0,0,1] op_sel_hi:[1,0,1]
    v_pk_fma_f32 v[110:111], v[150:151], v[58:59], v[58:59] op_sel:[0,0,1] op_sel_hi:[1,0,1]
    s_waitcnt lgkmcnt(0)
    s_barrier
    ds_read_b32 v250, v252
    v_pk_fma_f32 v[92:93], v[132:133], v[56:57], v[56:57] op_sel:[0,0,1] op_sel_hi:[1,0,1]
    v_pk_fma_f32 v[112:113], v[152:153], v[58:59], v[58:59] op_sel:[0,0,1] op_sel_hi:[1,0,1]
    v_pk_fma_f32 v[94:95], v[134:135], v[56:57], v[56:57] op_sel:[0,0,1] op_sel_hi:[1,0,1]
    v_pk_fma_f32 v[114:115], v[154:155], v[58:59], v[58:59] op_sel:[0,0,1] op_sel_hi:[1,0,1]
    v_pk_fma_f32 v[96:97], v[136:137], v[56:57], v[56:57] op_sel:[0,0,1] op_sel_hi:[1,0,1]
    v_pk_fma_f32 v[116:117], v[156:157], v[58:59], v[58:59] op_sel:[0,0,1] op_sel_hi:[1,0,1]
    v_pk_fma_f32 v[98:99], v[138:139], v[56:57], v[56:57] op_sel:[0,0,1] op_sel_hi:[1,0,1]
    v_pk_fma_f32 v[118:119], v[158:159], v[58:59], v[58:59] op_sel:[0,0,1] op_sel_hi:[1,0,1]
L_padc2:
    s_cbranch_execz L_backc
    s_cmp_lg_u32 s74, 0
    s_waitcnt lgkmcnt(0)
    s_cbranch_scc1 L_nokey2
    buffer_store_dwordx4 v[250:253], v254, s[44:47], 0 offen sc1
L_nokey2:
    ds_read_b128 v[168:171], v9 offset:7680
    ds_read_b128 v[188:191], v9 offset:10240
    ds_read_b128 v[172:175], v9 offset:8192
    ds_read_b128 v[192:195], v9 offset:10752
    ds_read_b128 v[176:179], v9 offset:8704
    ds_read_b128 v[196:199], v9 offset:11264
    ds_read_b128 v[180:183], v9 offset:9216
    ds_read_b128 v[200:203], v9 offset:11776
    ds_read_b128 v[184:187], v9 offset:9728
    ds_read_b128 v[204:207], v9 offset:12288
    ds_read_b128 v[228:231], v9 offset:12800
    ds_read_b128 v[232:235], v9 offset:13312
    ds_read_b128 v[236:239], v9 offset:13824
    ds_read_b128 v[240:243], v9 offset:14336
    ds_read_b128 v[244:247], v9 offset:14848
    v_and_b32 v2, 0xfff, v250
    v_sub_u32_e64 v2, v2, v11
    v_cmp_eq_u32 s[84:85], 0, v2
    v_cmp_eq_u32 s[86:87], 1, v2
    v_pk_fma_f32 v[100:101], v[140:141], v[56:57], v[56:57] op_sel:[0,0,1] op_sel_hi:[1,0,1]
    v_pk_fma_f32 v[120:121], v[160:161], v[58:59], v[58:59] op_sel:[0,0,1] op_sel_hi:[1,0,1]
    v_pk_fma_f32 v[102:103], v[142:143], v[56:57], v[56:57] op_sel:[0,0,1] op_sel_hi:[1,0,1]
    v_pk_fma_f32 v[122:123], v[162:163], v[58:59], v[58:59] op_sel:[0,0,1] op_sel_hi:[1,0,1]
    v_pk_fma_f32 v[104:105], v[144:145], v[56:57], v[56:57] op_sel:[0,0,1] op_sel_hi:[1,0,1]
    v_pk_fma_f32 v[124:125], v[164:165], v[58:59], v[58:59] op_sel:[0,0,1] op_sel_hi:[1,0,1]
    v_pk_fma_f32 v[106:107], v[146:147], v[56:57], v[56:57] op_sel:[0,0,1] op_sel_hi:[1,0,1]
    v_pk_fma_f32 v[126:127], v[166:167], v[58:59], v[58:59] op_sel:[0,0,1] op_sel_hi:[1,0,1]
    s_waitcnt lgkmcnt(5)
    v_pk_fma_f32 v[88:89], v[88:89], v[168:169], v[188:189]
    v_pk_fma_f32 v[108:109], v[108:109], v[168:169], v[188:189]
    v_pk_fma_f32 v[90:91], v[90:91], v[170:171], v[190:191]
    v_pk_fma_f32 v[110:111], v[110:111], v[170:171], v[190:191]
    v_pk_fma_f32 v[92:93], v[92:93], v[172:173], v[192:193]
    v_pk_fma_f32 v[112:113], v[112:113], v[172:173], v[192:193]
    v_pk_fma_f32 v[94:95], v[94:95], v[174:175], v[194:195]
    v_pk_fma_f32 v[114:115], v[114:115], v[174:175], v[194:195]
    v_pk_fma_f32 v[96:97], v[96:97], v[176:177], v[196:197]
    v_pk_fma_f32 v[116:117], v[116:117], v[176:177], v[196:197]
    v_pk_fma_f32 v[98:99], v[98:99], v[178:179], v[198:199]
    v_pk_fma_f32 v[118:119], v[118:119], v[178:179], v[198:199]
    v_pk_fma_f32 v[100:101], v[100:101], v[180:181], v[200:201]
    v_pk_fma_f32 v[120:121], v[120:121], v[180:181], v[200:201]
    v_pk_fma_f32 v[102:103], v[102:103], v[182:183], v[202:203]
    v_pk_fma_f32 v[122:123], v[122:123], v[182:183], v[202:203]
    v_pk_fma_f32 v[104:105], v[104:105], v[184:185], v[204:205]
    v_pk_fma_f32 v[124:125], v[124:125], v[184:185], v[204:205]
    v_pk_fma_f32 v[106:107], v[106:107], v[186:187], v[206:207]
    v_pk_fma_f32 v[126:127], v[126:127], v[186:187], v[206:207]
    v_mov_b32 v14, s94
    s_mov_b32 s82, 196608
    s_cmp_eq_u64 s[84:85], 0
    s_cbranch_scc1 L_norow20
    s_mov_b64 exec, s[84:85]
    v_cvt_pk_bf16_f32 v2, v88, v89
    v_lshl_or_b32 v16, v2, 16, v14
    v_and_or_b32 v17, v2, s91, v14
    v_cvt_pk_bf16_f32 v2, v90, v91
    v_lshl_or_b32 v18, v2, 16, v14
    v_and_or_b32 v19, v2, s91, v14
    buffer_store_dwordx4 v[16:19], v3, s[44:47], s82 offen offset:0 sc1
    v_cvt_pk_bf16_f32 v2, v92, v93
    v_lshl_or_b32 v20, v2, 16, v14
    v_and_or_b32 v21, v2, s91, v14
    v_cvt_pk_bf16_f32 v2, v94, v95
    v_lshl_or_b32 v22, v2, 16, v14
    v_and_or_b32 v23, v2, s91, v14
    buffer_store_dwordx4 v[20:23], v3, s[44:47], s82 offen offset:512 sc1
    v_cvt_pk_bf16_f32 v2, v96, v97
    v_lshl_or_b32 v24, v2, 16, v14
    v_and_or_b32 v25, v2, s91, v14
    v_cvt_pk_bf16_f32 v2, v98, v99
    v_lshl_or_b32 v26, v2, 16, v14
    v_and_or_b32 v27, v2, s91, v14
    buffer_store_dwordx4 v[24:27], v3, s[44:47], s82 offen offset:1024 sc1
    v_cvt_pk_bf16_f32 v2, v100, v101
    v_lshl_or_b32 v28, v2, 16, v14
    v_and_or_b32 v29, v2, s91, v14
    v_cvt_pk_bf16_f32 v2, v102, v103
    v_lshl_or_b32 v30, v2, 16, v14
    v_and_or_b32 v31, v2, s91, v14
    buffer_store_dwordx4 v[28:31], v3, s[44:47], s82 offen offset:1536 sc1
    v_cvt_pk_bf16_f32 v2, v104, v105
    v_lshl_or_b32 v32, v2, 16, v14
    v_and_or_b32 v33, v2, s91, v14
    v_cvt_pk_bf16_f32 v2, v106, v107
    v_lshl_or_b32 v34, v2, 16, v14
    v_and_or_b32 v35, v2, s91, v14
    buffer_store_dwordx4 v[32:35], v3, s[44:47], s82 offen offset:2048 sc1
    s_mov_b64 exec, -1
L_norow20:
    s_cmp_eq_u64 s[86:87], 0
    s_cbranch_scc1 L_norow21
    s_mov_b64 exec, s[86:87]
    v_cvt_pk_bf16_f32 v2, v108, v109
    v_lshl_or_b32 v16, v2, 16, v14
    v_and_or_b32 v17, v2, s91, v14
    v_cvt_pk_bf16_f32 v2, v110, v111
    v_lshl_or_b32 v18, v2, 16, v14
    v_and_or_b32 v19, v2, s91, v14
    buffer_store_dwordx4 v[16:19], v3, s[44:47], s82 offen offset:0 sc1
    v_cvt_pk_bf16_f32 v2, v112, v113
    v_lshl_or_b32 v20, v2, 16, v14
    v_and_or_b32 v21, v2, s91, v14
    v_cvt_pk_bf16_f32 v2, v114, v115
    v_lshl_or_b32 v22, v2, 16, v14
    v_and_or_b32 v23, v2, s91, v14
    buffer_store_dwordx4 v[20:23], v3, s[44:47], s82 offen offset:512 sc1
    v_cvt_pk_bf16_f32 v2, v116, v117
    v_lshl_or_b32 v24, v2, 16, v14
    v_and_or_b32 v25, v2, s91, v14
    v_cvt_pk_bf16_f32 v2, v118, v119
    v_lshl_or_b32 v26, v2, 16, v14
    v_and_or_b32 v27, v2, s91, v14
    buffer_store_dwordx4 v[24:27], v3, s[44:47], s82 offen offset:1024 sc1
    v_cvt_pk_bf16_f32 v2, v120, v121
    v_lshl_or_b32 v28, v2, 16, v14
    v_and_or_b32 v29, v2, s91, v14
    v_cvt_pk_bf16_f32 v2, v122, v123
    v_lshl_or_b32 v30, v2, 16, v14
    v_and_or_b32 v31, v2, s91, v14
    buffer_store_dwordx4 v[28:31], v3, s[44:47], s82 offen offset:1536 sc1
    v_cvt_pk_bf16_f32 v2, v124, v125
    v_lshl_or_b32 v32, v2, 16, v14
    v_and_or_b32 v33, v2, s91, v14
    v_cvt_pk_bf16_f32 v2, v126, v127
    v_lshl_or_b32 v34, v2, 16, v14
    v_and_or_b32 v35, v2, s91, v14
    buffer_store_dwordx4 v[32:35], v3, s[44:47], s82 offen offset:2048 sc1
    s_mov_b64 exec, -1
L_norow21:
    s_waitcnt lgkmcnt(0)
    v_mul_u32_u24 v2, 1272, v5
    v_add_u32 v8, v2, v4
    v_pk_fma_f32 v[128:129], v[228:229], v[88:89], v[128:129]
    v_pk_fma_f32 v[130:131], v[230:231], v[90:91], v[130:131]
    v_cvt_pk_bf16_f32 v36, v128, v129
    v_cvt_pk_bf16_f32 v37, v130, v131
    v_pk_fma_f32 v[148:149], v[228:229], v[108:109], v[148:149]
    v_pk_fma_f32 v[150:151], v[230:231], v[110:111], v[150:151]
    v_cvt_pk_bf16_f32 v38, v148, v149
    v_cvt_pk_bf16_f32 v39, v150, v151
    v_pk_fma_f32 v[132:133], v[232:233], v[92:93], v[132:133]
    v_pk_fma_f32 v[134:135], v[234:235], v[94:95], v[134:135]
    v_cvt_pk_bf16_f32 v40, v132, v133
    v_cvt_pk_bf16_f32 v41, v134, v135
    v_pk_fma_f32 v[152:153], v[232:233], v[112:113], v[152:153]
    v_pk_fma_f32 v[154:155], v[234:235], v[114:115], v[154:155]
    v_cvt_pk_bf16_f32 v42, v152, v153
    v_cvt_pk_bf16_f32 v43, v154, v155
    v_pk_fma_f32 v[136:137], v[236:237], v[96:97], v[136:137]
    v_pk_fma_f32 v[138:139], v[238:239], v[98:99], v[138:139]
    v_cvt_pk_bf16_f32 v44, v136, v137
    v_cvt_pk_bf16_f32 v45, v138, v139
    v_pk_fma_f32 v[156:157], v[236:237], v[116:117], v[156:157]
    v_pk_fma_f32 v[158:159], v[238:239], v[118:119], v[158:159]
    v_cvt_pk_bf16_f32 v46, v156, v157
    v_cvt_pk_bf16_f32 v47, v158, v159
    v_pk_fma_f32 v[140:141], v[240:241], v[100:101], v[140:141]
    v_pk_fma_f32 v[142:143], v[242:243], v[102:103], v[142:143]
    v_cvt_pk_bf16_f32 v48, v140, v141
    v_cvt_pk_bf16_f32 v49, v142, v143
    v_pk_fma_f32 v[160:161], v[240:241], v[120:121], v[160:161]
    v_pk_fma_f32 v[162:163], v[242:243], v[122:123], v[162:163]
    v_cvt_pk_bf16_f32 v50, v160, v161
    v_cvt_pk_bf16_f32 v51, v162, v163
    v_pk_fma_f32 v[144:145], v[244:245], v[104:105], v[144:145]
    v_pk_fma_f32 v[146:147], v[246:247], v[106:107], v[146:147]
    v_cvt_pk_bf16_f32 v52, v144, v145
    v_cvt_pk_bf16_f32 v53, v146, v147
    v_pk_fma_f32 v[164:165], v[244:245], v[124:125], v[164:165]
    v_pk_fma_f32 v[166:167], v[246:247], v[126:127], v[166:167]
    v_cvt_pk_bf16_f32 v54, v164, v165
    v_cvt_pk_bf16_f32 v55, v166, v167
    s_nop 0
    v_permlane16_swap_b32 v36, v38
    v_permlane16_swap_b32 v37, v39
    v_permlane16_swap_b32 v40, v42
    v_permlane16_swap_b32 v41, v43
    v_permlane16_swap_b32 v44, v46
    v_permlane16_swap_b32 v45, v47
    v_permlane16_swap_b32 v48, v50
    v_permlane16_swap_b32 v49, v51
    v_permlane16_swap_b32 v52, v54
    v_permlane16_swap_b32 v53, v55
    s_or_b64 vcc, s[84:85], s[86:87]
    s_cbranch_scc1 L_win2
    buffer_store_dwordx4 v[36:39], v8, s[52:55], 0 offen offset:0
    buffer_store_dwordx4 v[40:43], v8, s[52:55], 0 offen offset:256
    buffer_store_dwordx4 v[44:47], v8, s[52:55], 0 offen offset:512
    buffer_store_dwordx4 v[48:51], v8, s[52:55], 0 offen offset:768
    buffer_store_dwordx4 v[52:55], v8, s[52:55], 0 offen offset:1024
    s_endpgm
L_win2:
    s_mov_b32 s4, 0xffff
    s_mov_b32 s5, 0xffff
    s_and_b64 s[84:85], s[84:85], s[4:5]
    s_andn2_b64 s[86:87], s[86:87], s[4:5]
    s_or_b64 vcc, s[84:85], s[86:87]
    s_mov_b64 exec, vcc
    buffer_store_dwordx4 v[36:39], v8, s[52:55], 0 offen offset:0 sc1
    buffer_store_dwordx4 v[40:43], v8, s[52:55], 0 offen offset:256 sc1
    buffer_store_dwordx4 v[44:47], v8, s[52:55], 0 offen offset:512 sc1
    buffer_store_dwordx4 v[48:51], v8, s[52:55], 0 offen offset:768 sc1
    buffer_store_dwordx4 v[52:55], v8, s[52:55], 0 offen offset:1024 sc1
    s_not_b64 exec, vcc
    buffer_store_dwordx4 v[36:39], v8, s[52:55], 0 offen offset:0
    buffer_store_dwordx4 v[40:43], v8, s[52:55], 0 offen offset:256
    buffer_store_dwordx4 v[44:47], v8, s[52:55], 0 offen offset:512
    buffer_store_dwordx4 v[48:51], v8, s[52:55], 0 offen offset:768
    buffer_store_dwordx4 v[52:55], v8, s[52:55], 0 offen offset:1024
    s_mov_b64 exec, 0xff
    s_mov_b32 s82, 163840
    s_waitcnt vmcnt(0)
    buffer_store_dwordx4 v[250:253], v254, s[44:47], s82 offen sc1
    s_mov_b64 exec, -1
    s_endpgm
L_yre2:
    s_sub_u32 s90, s90, 1
    s_cbranch_scc1 L_yok2
    v_cmp_eq_u32 s[4:5], -1, v36
    v_cmp_eq_u32 s[6:7], -1, v40
    v_cmp_eq_u32 s[8:9], -1, v44
    v_cmp_eq_u32 s[10:11], -1, v48
    v_cmp_eq_u32 s[12:13], -1, v52
    s_mov_b64 exec, s[4:5]
    buffer_load_dwordx4 v[36:39], v6, s[44:47], 0 offen sc1
    s_mov_b64 exec, s[6:7]
    buffer_load_dwordx4 v[40:43], v6, s[44:47], s76 offen sc1
    s_mov_b64 exec, s[8:9]
    buffer_load_dwordx4 v[44:47], v6, s[44:47], s77 offen sc1
    s_mov_b64 exec, s[10:11]
    buffer_load_dwordx4 v[48:51], v6, s[44:47], s78 offen sc1
    s_mov_b64 exec, s[12:13]
    buffer_load_dwordx4 v[52:55], v6, s[44:47], s79 offen sc1
    s_mov_b64 exec, -1
    s_waitcnt vmcnt(0)
    s_branch L_ychk2
L_modre2:
    s_sub_u32 s90, s90, 1
    s_cbranch_scc1 L_modok2
    buffer_load_dwordx4 v[208:211], v7, s[44:47], 0 offen offset:0 sc1
    buffer_load_dwordx4 v[212:215], v7, s[44:47], 0 offen offset:2560 sc1
    buffer_load_dwordx4 v[216:219], v7, s[44:47], s80 offen offset:0 sc1
    buffer_load_dwordx4 v[220:223], v7, s[44:47], s80 offen offset:2560 sc1
    buffer_load_dwordx4 v[224:227], v7, s[44:47], s81 offen offset:0 sc1
    buffer_load_dwordx4 v[228:231], v7, s[44:47], s81 offen offset:2560 sc1
    s_waitcnt vmcnt(0)
    s_branch L_modchk2
L_ln1:
    ds_read_b64 v[16:17], v253 offset:0
    ds_read_b64 v[18:19], v253 offset:256
    ds_read_b64 v[20:21], v253 offset:512
    ds_read_b64 v[22:23], v253 offset:768
    ds_read_b64 v[24:25], v253 offset:1024
    buffer_load_dwordx4 v[208:211], v7, s[44:47], 0 offen offset:0 sc1
    v_lshrrev_b32 v2, 4, v0
    v_xor_b32 v2, v2, v0
    v_and_b32 v2, 3, v2
    v_lshrrev_b32 v248, 2, v0
    v_lshlrev_b32 v248, 7, v248
    v_lshl_add_u32 v248, v2, 4, v248
    s_lshl_b32 s84, s37, 3
    buffer_load_dwordx4 v[212:215], v7, s[44:47], 0 offen offset:2560 sc1
    s_add_u32 s84, s84, s56
    v_add_u32 v248, s84, v248
    s_cmp_lt_u32 s74, 2
    s_cselect_b32 s84, 0, 0x80000000
    v_add_u32 v250, s84, v248
    s_lshl_b32 m0, s74, 10
    v_lshrrev_b32 v2, 2, v14
    buffer_load_dwordx4 v[216:219], v7, s[44:47], s80 offen offset:0 sc1
    v_xor_b32 v2, s74, v2
    v_and_b32 v2, 3, v2
    v_lshlrev_b32 v249, 6, v14
    v_lshl_add_u32 v249, v2, 4, v249
    v_and_b32 v2, 1, v13
    v_lshl_add_u32 v249, v2, 3, v249
    s_mov_b32 s82, 0x3acccccd
    buffer_load_dwordx4 v[220:223], v7, s[44:47], s80 offen offset:2560 sc1
    v_mov_b32 v65, 0x3727c5ac
    v_bfrev_b32 v66, 1
    s_waitcnt lgkmcnt(0)
    v_lshlrev_b32 v88, 16, v16
    v_and_b32 v89, s91, v16
    v_lshlrev_b32 v90, 16, v17
    v_and_b32 v91, s91, v17
    buffer_load_dwordx4 v[224:227], v7, s[44:47], s81 offen offset:0 sc1
    v_lshlrev_b32 v92, 16, v18
    v_and_b32 v93, s91, v18
    v_lshlrev_b32 v94, 16, v19
    v_and_b32 v95, s91, v19
    v_lshlrev_b32 v96, 16, v20
    v_and_b32 v97, s91, v20
    v_lshlrev_b32 v98, 16, v21
    buffer_load_dwordx4 v[228:231], v7, s[44:47], s81 offen offset:2560 sc1
    v_and_b32 v99, s91, v21
    v_lshlrev_b32 v100, 16, v22
    v_and_b32 v101, s91, v22
    v_lshlrev_b32 v102, 16, v23
    v_and_b32 v103, s91, v23
    v_lshlrev_b32 v104, 16, v24
    v_and_b32 v105, s91, v24
    v_lshlrev_b32 v106, 16, v25
    v_and_b32 v107, s91, v25
    v_pk_add_f32 v[68:69], v[88:89], v[92:93]
    v_pk_add_f32 v[70:71], v[90:91], v[94:95]
    v_pk_add_f32 v[68:69], v[68:69], v[96:97]
    v_pk_add_f32 v[70:71], v[70:71], v[98:99]
    v_pk_add_f32 v[68:69], v[68:69], v[100:101]
    v_pk_add_f32 v[70:71], v[70:71], v[102:103]
    v_pk_add_f32 v[68:69], v[68:69], v[104:105]
    v_pk_add_f32 v[70:71], v[70:71], v[106:107]
    v_pk_add_f32 v[68:69], v[68:69], v[70:71]
    v_add_f32_e64 v60, v68, v69
    v_pk_mul_f32 v[80:81], v[88:89], v[88:89]
    v_pk_fma_f32 v[80:81], v[90:91], v[90:91], v[80:81]
    v_pk_fma_f32 v[80:81], v[92:93], v[92:93], v[80:81]
    v_pk_fma_f32 v[80:81], v[94:95], v[94:95], v[80:81]
    v_pk_fma_f32 v[80:81], v[96:97], v[96:97], v[80:81]
    v_pk_fma_f32 v[80:81], v[98:99], v[98:99], v[80:81]
    v_pk_fma_f32 v[80:81], v[100:101], v[100:101], v[80:81]
    v_pk_fma_f32 v[80:81], v[102:103], v[102:103], v[80:81]
    v_pk_fma_f32 v[80:81], v[104:105], v[104:105], v[80:81]
    v_pk_fma_f32 v[80:81], v[106:107], v[106:107], v[80:81]
    v_add_f32 v56, v80, v81
    s_nop 1
    v_permlane16_swap_b32 v60, v56
    v_add_f32 v60, v60, v56
    s_nop 1
    v_add_f32_dpp v60, v60, v60 row_ror:8 row_mask:0xf bank_mask:0xf
    s_nop 1
    v_add_f32_dpp v60, v60, v60 row_ror:4 row_mask:0xf bank_mask:0xf
    s_nop 1
    v_add_f32_dpp v60, v60, v60 row_ror:2 row_mask:0xf bank_mask:0xf
    s_nop 1
    v_add_f32_dpp v56, v60, v60 row_ror:1 row_mask:0xf bank_mask:0xf
    v_add_f32_dpp v60, v60, v60 row_ror:1 row_mask:0xf bank_mask:0xf
    s_nop 1
    v_permlane16_swap_b32 v60, v56
    v_mul_f32 v60, s82, v60
    v_fma_f32 v56, v56, s82, v65
    v_fma_f32 v56, -v60, v60, v56
    v_max_f32 v56, v65, v56
    v_rsq_f32 v56, v56
    s_lshl_b32 s83, s3, 4
    v_add_u32 v11, s83, v13
    v_mul_f32 v57, -v60, v56
    v_mov_b32 v10, v11
    v_pk_fma_f32 v[128:129], v[88:89], v[56:57], v[56:57] op_sel:[0,0,1] op_sel_hi:[1,0,1]
    v_pk_fma_f32 v[130:131], v[90:91], v[56:57], v[56:57] op_sel:[0,0,1] op_sel_hi:[1,0,1]
    v_pk_fma_f32 v[132:133], v[92:93], v[56:57], v[56:57] op_sel:[0,0,1] op_sel_hi:[1,0,1]
    v_pk_fma_f32 v[134:135], v[94:95], v[56:57], v[56:57] op_sel:[0,0,1] op_sel_hi:[1,0,1]
    v_pk_fma_f32 v[136:137], v[96:97], v[56:57], v[56:57] op_sel:[0,0,1] op_sel_hi:[1,0,1]
    v_pk_fma_f32 v[138:139], v[98:99], v[56:57], v[56:57] op_sel:[0,0,1] op_sel_hi:[1,0,1]
    v_pk_fma_f32 v[140:141], v[100:101], v[56:57], v[56:57] op_sel:[0,0,1] op_sel_hi:[1,0,1]
    v_pk_fma_f32 v[142:143], v[102:103], v[56:57], v[56:57] op_sel:[0,0,1] op_sel_hi:[1,0,1]
    v_pk_fma_f32 v[144:145], v[104:105], v[56:57], v[56:57] op_sel:[0,0,1] op_sel_hi:[1,0,1]
    v_pk_fma_f32 v[146:147], v[106:107], v[56:57], v[56:57] op_sel:[0,0,1] op_sel_hi:[1,0,1]
    s_mul_i32 s83, s3, 2560
    v_and_b32 v2, 31, v1
    v_lshl_add_u32 v3, v2, 4, s83
    v_mov_b32 v252, 88576
    v_mov_b32 v2, 0
    ds_write_b32 v252, v2
    s_mov_b32 s14, 1
    s_mov_b32 s15, 1
    s_movk_i32 s83, 0xf000
    v_lshlrev_b32 v204, 16, v232
    v_and_b32 v205, s91, v232
    v_lshlrev_b32 v206, 16, v233
    v_and_b32 v207, s91, v233
    s_mov_b32 s90, 131072
    s_waitcnt vmcnt(0)
L_modchk1:
    v_xor_b32_e64 v2, s94, v208
    v_bitop3_b32 v2, v2, v213, s94 bitop3:0xf6
    v_bitop3_b32 v2, v2, v218, s94 bitop3:0xf6
    v_bitop3_b32 v2, v2, v223, s94 bitop3:0xf6
    v_bitop3_b32 v2, v2, v224, s94 bitop3:0xf6
    v_bitop3_b32 v2, v2, v229, s94 bitop3:0xf6
    v_and_b32 v2, 0xffff, v2
    v_cmp_ne_u32 vcc, 0, v2
    s_cbranch_vccnz L_modre1
L_modok1:
    buffer_load_dwordx4 v248, s[44:47], 0 offen sc1 lds
    s_add_u32 m0, m0, 4096
    v_and_b32 v212, s91, v212
    v_and_b32 v213, s91, v213
    v_and_b32 v214, s91, v214
    v_and_b32 v215, s91, v215
    v_and_b32 v216, s91, v216
    v_and_b32 v217, s91, v217
    v_and_b32 v218, s91, v218
    buffer_load_dwordx4 v248, s[44:47], s77 offen sc1 lds
    s_add_u32 m0, m0, 4096
    v_and_b32 v219, s91, v219
    v_pk_fma_f32 v[212:213], v[212:213], v[216:217], v[216:217]
    v_pk_fma_f32 v[214:215], v[214:215], v[218:219], v[218:219]
    ds_write_b128 v8, v[212:215] offset:0
    v_and_b32 v208, s91, v208
    v_and_b32 v209, s91, v209
    v_and_b32 v210, s91, v210
    buffer_load_dwordx4 v250, s[44:47], s79 offen sc1 lds
    v_and_b32 v211, s91, v211
    v_pk_mul_f32 v[208:209], v[208:209], v[216:217]
    v_pk_mul_f32 v[210:211], v[210:211], v[218:219]
    ds_write_b128 v8, v[208:211] offset:2560
    v_and_b32 v224, s91, v224
    v_and_b32 v225, s91, v225
    v_and_b32 v226, s91, v226
    v_and_b32 v227, s91, v227
    v_pk_add_f32 v[224:225], v[224:225], 1.0 op_sel_hi:[1,0]
    v_pk_add_f32 v[226:227], v[226:227], 1.0 op_sel_hi:[1,0]
    v_pk_mul_f32 v[204:205], v[204:205], v[224:225]
    v_pk_mul_f32 v[206:207], v[206:207], v[226:227]
    ds_write_b128 v8, v[204:207] offset:5120
    s_mov_b32 s90, 131072
    s_waitcnt lgkmcnt(0)
    s_barrier
    ds_read_b128 v[168:171], v9 offset:0
    ds_read_b128 v[188:191], v9 offset:2560
    ds_read_b128 v[172:175], v9 offset:512
    ds_read_b128 v[192:195], v9 offset:3072
    v_and_b32 v220, s91, v220
    ds_read_b128 v[176:179], v9 offset:1024
    v_and_b32 v221, s91, v221
    ds_read_b128 v[196:199], v9 offset:3584
    v_and_b32 v222, s91, v222
    ds_read_b128 v[180:183], v9 offset:1536
    v_and_b32 v223, s91, v223
    ds_read_b128 v[200:203], v9 offset:4096
    v_and_b32 v228, s91, v228
    ds_read_b128 v[184:187], v9 offset:2048
    v_and_b32 v229, s91, v229
    ds_read_b128 v[204:207], v9 offset:4608
    v_and_b32 v230, s91, v230
    ds_read_b128 v[148:151], v9 offset:5120
    v_and_b32 v231, s91, v231
    ds_read_b128 v[152:155], v9 offset:5632
    ds_read_b128 v[156:159], v9 offset:6144
    ds_read_b128 v[160:163], v9 offset:6656
    ds_read_b128 v[164:167], v9 offset:7168
    s_waitcnt lgkmcnt(5)
    v_pk_fma_f32 v[128:129], v[128:129], v[168:169], v[188:189]
    v_pk_fma_f32 v[130:131], v[130:131], v[170:171], v[190:191]
    v_pk_fma_f32 v[132:133], v[132:133], v[172:173], v[192:193]
    v_pk_fma_f32 v[134:135], v[134:135], v[174:175], v[194:195]
    v_pk_fma_f32 v[136:137], v[136:137], v[176:177], v[196:197]
    v_pk_fma_f32 v[138:139], v[138:139], v[178:179], v[198:199]
    v_pk_fma_f32 v[140:141], v[140:141], v[180:181], v[200:201]
    v_pk_fma_f32 v[142:143], v[142:143], v[182:183], v[202:203]
    v_pk_fma_f32 v[144:145], v[144:145], v[184:185], v[204:205]
    v_pk_fma_f32 v[146:147], v[146:147], v[186:187], v[206:207]
    s_waitcnt lgkmcnt(0)
    ds_write_b128 v8, v[224:227] offset:7680
    v_pk_add_f32 v[76:77], v[148:149], v[152:153]
    v_pk_add_f32 v[78:79], v[150:151], v[154:155]
    v_pk_add_f32 v[76:77], v[76:77], v[156:157]
    v_pk_add_f32 v[78:79], v[78:79], v[158:159]
    ds_write_b128 v8, v[220:223] offset:10240
    v_pk_add_f32 v[76:77], v[76:77], v[160:161]
    v_pk_add_f32 v[78:79], v[78:79], v[162:163]
    v_pk_add_f32 v[76:77], v[76:77], v[164:165]
    v_pk_add_f32 v[78:79], v[78:79], v[166:167]
    ds_write_b128 v8, v[228:231] offset:12800
    v_pk_add_f32 v[76:77], v[76:77], v[78:79]
    v_add_f32_e64 v64, v76, v77
    s_waitcnt vmcnt(0)
    s_barrier
    ds_read_b64 v[36:37], v249 offset:0
    ds_read_b64 v[38:39], v249 offset:2048
    ds_read_b64 v[40:41], v249 offset:4096
    ds_read_b64 v[42:43], v249 offset:6144
    ds_read_b64 v[44:45], v249 offset:8192
    s_waitcnt lgkmcnt(0)
L_ychk1:
    v_max3_u32 v2, v36, v38, v40
    v_max3_u32 v2, v2, v42, v44
    v_cmp_eq_u32 vcc, -1, v2
    s_cbranch_vccnz L_yre1
L_yok1:
    v_lshlrev_b32 v16, 16, v36
    v_and_b32 v17, s91, v36
    v_lshlrev_b32 v18, 16, v37
    v_and_b32 v19, s91, v37
    v_pk_fma_f32 v[128:129], v[128:129], v[16:17], v[88:89]
    v_pk_fma_f32 v[130:131], v[130:131], v[18:19], v[90:91]
    v_lshlrev_b32 v20, 16, v38
    v_and_b32 v21, s91, v38
    v_lshlrev_b32 v22, 16, v39
    v_and_b32 v23, s91, v39
    v_pk_fma_f32 v[132:133], v[132:133], v[20:21], v[92:93]
    v_pk_fma_f32 v[134:135], v[134:135], v[22:23], v[94:95]
    v_lshlrev_b32 v24, 16, v40
    v_and_b32 v25, s91, v40
    v_lshlrev_b32 v26, 16, v41
    v_and_b32 v27, s91, v41
    v_pk_fma_f32 v[136:137], v[136:137], v[24:25], v[96:97]
    v_pk_fma_f32 v[138:139], v[138:139], v[26:27], v[98:99]
    v_lshlrev_b32 v28, 16, v42
    v_and_b32 v29, s91, v42
    v_lshlrev_b32 v30, 16, v43
    v_and_b32 v31, s91, v43
    v_pk_fma_f32 v[140:141], v[140:141], v[28:29], v[100:101]
    v_pk_fma_f32 v[142:143], v[142:143], v[30:31], v[102:103]
    v_lshlrev_b32 v32, 16, v44
    v_and_b32 v33, s91, v44
    v_lshlrev_b32 v34, 16, v45
    v_and_b32_e64 v35, s91, v45
    v_pk_fma_f32 v[144:145], v[144:145], v[32:33], v[104:105]
    v_pk_fma_f32 v[146:147], v[146:147], v[34:35], v[106:107]
    v_pk_add_f32 v[68:69], v[128:129], v[132:133]
    v_pk_add_f32 v[70:71], v[130:131], v[134:135]
    v_pk_add_f32 v[68:69], v[68:69], v[136:137]
    v_pk_add_f32 v[70:71], v[70:71], v[138:139]
    v_pk_add_f32 v[68:69], v[68:69], v[140:141]
    v_pk_add_f32 v[70:71], v[70:71], v[142:143]
    v_pk_add_f32 v[68:69], v[68:69], v[144:145]
    v_pk_add_f32 v[70:71], v[70:71], v[146:147]
    v_pk_add_f32 v[68:69], v[68:69], v[70:71]
    v_add_f32_e64 v60, v68, v69
    v_pk_mul_f32 v[80:81], v[128:129], v[128:129]
    v_pk_mul_f32 v[84:85], v[128:129], v[148:149]
    v_pk_fma_f32 v[80:81], v[130:131], v[130:131], v[80:81]
    v_pk_fma_f32 v[84:85], v[130:131], v[150:151], v[84:85]
    v_pk_fma_f32 v[80:81], v[132:133], v[132:133], v[80:81]
    v_pk_fma_f32 v[84:85], v[132:133], v[152:153], v[84:85]
    v_pk_fma_f32 v[80:81], v[134:135], v[134:135], v[80:81]
    v_pk_fma_f32 v[84:85], v[134:135], v[154:155], v[84:85]
    v_pk_fma_f32 v[80:81], v[136:137], v[136:137], v[80:81]
    v_pk_fma_f32 v[84:85], v[136:137], v[156:157], v[84:85]
    v_pk_fma_f32 v[80:81], v[138:139], v[138:139], v[80:81]
    v_pk_fma_f32 v[84:85], v[138:139], v[158:159], v[84:85]
    v_pk_fma_f32 v[80:81], v[140:141], v[140:141], v[80:81]
    v_pk_fma_f32 v[84:85], v[140:141], v[160:161], v[84:85]
    v_pk_fma_f32 v[80:81], v[142:143], v[142:143], v[80:81]
    v_pk_fma_f32 v[84:85], v[142:143], v[162:163], v[84:85]
    v_pk_fma_f32 v[80:81], v[144:145], v[144:145], v[80:81]
    v_pk_fma_f32 v[84:85], v[144:145], v[164:165], v[84:85]
    v_pk_fma_f32 v[80:81], v[146:147], v[146:147], v[80:81]
    v_pk_fma_f32 v[84:85], v[146:147], v[166:167], v[84:85]
    v_add_f32 v56, v80, v81
    v_add_f32 v62, v84, v85
    s_nop 0
    v_permlane16_swap_b32 v60, v64
    v_permlane16_swap_b32 v56, v62
    v_add_f32 v60, v60, v64
    v_add_f32 v56, v56, v62
    s_nop 0
    v_add_f32_dpp v60, v60, v60 row_ror:8 row_mask:0xf bank_mask:0xf
    v_add_f32_dpp v56, v56, v56 row_ror:8 row_mask:0xf bank_mask:0xf
    s_nop 0
    v_add_f32_dpp v60, v60, v60 row_ror:4 row_mask:0xf bank_mask:0xf
    v_add_f32_dpp v56, v56, v56 row_ror:4 row_mask:0xf bank_mask:0xf
    s_nop 0
    v_add_f32_dpp v60, v60, v60 row_ror:2 row_mask:0xf bank_mask:0xf
    v_add_f32_dpp v56, v56, v56 row_ror:2 row_mask:0xf bank_mask:0xf
    s_nop 0
    v_add_f32_dpp v64, v60, v60 row_ror:1 row_mask:0xf bank_mask:0xf
    v_add_f32_dpp v62, v56, v56 row_ror:1 row_mask:0xf bank_mask:0xf
    v_add_f32_dpp v60, v60, v60 row_ror:1 row_mask:0xf bank_mask:0xf
    v_add_f32_dpp v56, v56, v56 row_ror:1 row_mask:0xf bank_mask:0xf
    s_nop 0
    v_permlane16_swap_b32 v60, v64
    v_permlane16_swap_b32 v56, v62
    v_mul_f32 v60, s82, v60
    v_fma_f32 v56, v56, s82, v65
    v_fma_f32 v56, -v60, v60, v56
    v_max_f32 v56, v65, v56
    v_rsq_f32 v56, v56
    v_fma_f32 v62, -v60, v64, v62
    v_mul_f32 v62, v62, v56
    v_ashrrev_i32 v68, 31, v62
    v_bitop3_b32 v68, v68, v66, v62 bitop3:0x56
    v_and_or_b32 v10, v68, s83, v10
    s_mov_b64 exec, s[14:15]
    ds_max_u32 v252, v10
    s_mov_b64 exec, -1
    v_mul_f32 v57, -v60, v56
    v_mov_b32 v251, s75
    v_pk_fma_f32 v[88:89], v[128:129], v[56:57], v[56:57] op_sel:[0,0,1] op_sel_hi:[1,0,1]
    v_pk_fma_f32 v[90:91], v[130:131], v[56:57], v[56:57] op_sel:[0,0,1] op_sel_hi:[1,0,1]
    v_pk_fma_f32 v[92:93], v[132:133], v[56:57], v[56:57] op_sel:[0,0,1] op_sel_hi:[1,0,1]
    v_pk_fma_f32 v[94:95], v[134:135], v[56:57], v[56:57] op_sel:[0,0,1] op_sel_hi:[1,0,1]
    s_waitcnt lgkmcnt(0)
    s_barrier
    ds_read_b32 v250, v252
    v_pk_fma_f32 v[96:97], v[136:137], v[56:57], v[56:57] op_sel:[0,0,1] op_sel_hi:[1,0,1]
    v_pk_fma_f32 v[98:99], v[138:139], v[56:57], v[56:57] op_sel:[0,0,1] op_sel_hi:[1,0,1]
    v_pk_fma_f32 v[100:101], v[140:141], v[56:57], v[56:57] op_sel:[0,0,1] op_sel_hi:[1,0,1]
    v_pk_fma_f32 v[102:103], v[142:143], v[56:57], v[56:57] op_sel:[0,0,1] op_sel_hi:[1,0,1]
    v_pk_fma_f32 v[104:105], v[144:145], v[56:57], v[56:57] op_sel:[0,0,1] op_sel_hi:[1,0,1]
    v_pk_fma_f32 v[106:107], v[146:147], v[56:57], v[56:57] op_sel:[0,0,1] op_sel_hi:[1,0,1]
    s_cmp_lg_u32 s74, 0
    s_waitcnt lgkmcnt(0)
    s_cbranch_scc1 L_nokey1
    buffer_store_dwordx4 v[250:253], v254, s[44:47], 0 offen sc1
L_nokey1:
    ds_read_b128 v[168:171], v9 offset:7680
    ds_read_b128 v[188:191], v9 offset:10240
    ds_read_b128 v[172:175], v9 offset:8192
    ds_read_b128 v[192:195], v9 offset:10752
    ds_read_b128 v[176:179], v9 offset:8704
    ds_read_b128 v[196:199], v9 offset:11264
    ds_read_b128 v[180:183], v9 offset:9216
    ds_read_b128 v[200:203], v9 offset:11776
    ds_read_b128 v[184:187], v9 offset:9728
    ds_read_b128 v[204:207], v9 offset:12288
    ds_read_b128 v[228:231], v9 offset:12800
    ds_read_b128 v[232:235], v9 offset:13312
    ds_read_b128 v[236:239], v9 offset:13824
    ds_read_b128 v[240:243], v9 offset:14336
    ds_read_b128 v[244:247], v9 offset:14848
    v_and_b32 v2, 0xfff, v250
    v_sub_u32 v2, v2, v11
    v_cmp_eq_u32 s[84:85], 0, v2
    s_waitcnt lgkmcnt(5)
    v_pk_fma_f32 v[88:89], v[88:89], v[168:169], v[188:189]
L_padc3:
    s_cbranch_execz L_backc
    v_pk_fma_f32 v[90:91], v[90:91], v[170:171], v[190:191]
    v_pk_fma_f32 v[92:93], v[92:93], v[172:173], v[192:193]
    v_pk_fma_f32 v[94:95], v[94:95], v[174:175], v[194:195]
    v_pk_fma_f32 v[96:97], v[96:97], v[176:177], v[196:197]
    v_pk_fma_f32 v[98:99], v[98:99], v[178:179], v[198:199]
    v_pk_fma_f32 v[100:101], v[100:101], v[180:181], v[200:201]
    v_pk_fma_f32 v[102:103], v[102:103], v[182:183], v[202:203]
    v_pk_fma_f32 v[104:105], v[104:105], v[184:185], v[204:205]
    v_pk_fma_f32 v[106:107], v[106:107], v[186:187], v[206:207]
    v_mov_b32 v14, s94
    s_mov_b32 s82, 196608
    s_cmp_eq_u64 s[84:85], 0
    s_cbranch_scc1 L_norow10
    s_mov_b64 exec, s[84:85]
    v_cvt_pk_bf16_f32 v2, v88, v89
    v_lshl_or_b32 v16, v2, 16, v14
    v_and_or_b32 v17, v2, s91, v14
    v_cvt_pk_bf16_f32 v2, v90, v91
    v_lshl_or_b32 v18, v2, 16, v14
    v_and_or_b32 v19, v2, s91, v14
    buffer_store_dwordx4 v[16:19], v3, s[44:47], s82 offen offset:0 sc1
    v_cvt_pk_bf16_f32 v2, v92, v93
    v_lshl_or_b32 v20, v2, 16, v14
    v_and_or_b32 v21, v2, s91, v14
    v_cvt_pk_bf16_f32 v2, v94, v95
    v_lshl_or_b32 v22, v2, 16, v14
    v_and_or_b32 v23, v2, s91, v14
    buffer_store_dwordx4 v[20:23], v3, s[44:47], s82 offen offset:512 sc1
    v_cvt_pk_bf16_f32 v2, v96, v97
    v_lshl_or_b32 v24, v2, 16, v14
    v_and_or_b32 v25, v2, s91, v14
    v_cvt_pk_bf16_f32 v2, v98, v99
    v_lshl_or_b32 v26, v2, 16, v14
    v_and_or_b32 v27, v2, s91, v14
    buffer_store_dwordx4 v[24:27], v3, s[44:47], s82 offen offset:1024 sc1
    v_cvt_pk_bf16_f32 v2, v100, v101
    v_lshl_or_b32 v28, v2, 16, v14
    v_and_or_b32 v29, v2, s91, v14
    v_cvt_pk_bf16_f32 v2, v102, v103
    v_lshl_or_b32 v30, v2, 16, v14
    v_and_or_b32 v31, v2, s91, v14
    buffer_store_dwordx4 v[28:31], v3, s[44:47], s82 offen offset:1536 sc1
    v_cvt_pk_bf16_f32 v2, v104, v105
    v_lshl_or_b32 v32, v2, 16, v14
    v_and_or_b32 v33, v2, s91, v14
    v_cvt_pk_bf16_f32 v2, v106, v107
    v_lshl_or_b32 v34, v2, 16, v14
    v_and_or_b32 v35, v2, s91, v14
    buffer_store_dwordx4 v[32:35], v3, s[44:47], s82 offen offset:2048 sc1
    s_mov_b64 exec, -1
L_norow10:
    s_waitcnt lgkmcnt(0)
    v_mul_u32_u24 v2, 248, v5
    v_add_u32_e64 v8, v2, v4
    v_lshl_add_u32 v9, v5, 31, v4
    v_pk_fma_f32 v[128:129], v[228:229], v[88:89], v[128:129]
    v_pk_fma_f32 v[130:131], v[230:231], v[90:91], v[130:131]
    v_cvt_pk_bf16_f32 v36, v128, v129
    v_cvt_pk_bf16_f32 v37, v130, v131
    v_pk_fma_f32 v[132:133], v[232:233], v[92:93], v[132:133]
    v_pk_fma_f32 v[134:135], v[234:235], v[94:95], v[134:135]
    v_cvt_pk_bf16_f32 v38, v132, v133
    v_cvt_pk_bf16_f32 v39, v134, v135
    v_pk_fma_f32 v[136:137], v[236:237], v[96:97], v[136:137]
    v_pk_fma_f32 v[138:139], v[238:239], v[98:99], v[138:139]
    v_cvt_pk_bf16_f32 v40, v136, v137
    v_cvt_pk_bf16_f32 v41, v138, v139
    v_pk_fma_f32 v[140:141], v[240:241], v[100:101], v[140:141]
    v_pk_fma_f32 v[142:143], v[242:243], v[102:103], v[142:143]
    v_cvt_pk_bf16_f32 v42, v140, v141
    v_cvt_pk_bf16_f32 v43, v142, v143
    v_pk_fma_f32 v[144:145], v[244:245], v[104:105], v[144:145]
    v_pk_fma_f32 v[146:147], v[246:247], v[106:107], v[146:147]
    v_cvt_pk_bf16_f32 v44, v144, v145
    v_cvt_pk_bf16_f32 v45, v146, v147
    s_nop 0
    v_permlane16_swap_b32 v36, v38
    v_permlane16_swap_b32 v37, v39
    v_permlane16_swap_b32 v40, v42
    v_permlane16_swap_b32 v41, v43
    v_permlane16_swap_b32 v44, v46
    v_permlane16_swap_b32 v45, v47
    s_or_b64 vcc, s[84:85], 0
    s_cbranch_scc1 L_win1
    buffer_store_dwordx4 v[36:39], v8, s[52:55], 0 offen offset:0
    buffer_store_dwordx4 v[40:43], v8, s[52:55], 0 offen offset:512
    buffer_store_dwordx4 v[44:47], v9, s[52:55], 0 offen offset:1024
    s_endpgm
L_win1:
    s_mov_b64 exec, vcc
    buffer_store_dwordx4 v[36:39], v8, s[52:55], 0 offen offset:0 sc1
    buffer_store_dwordx4 v[40:43], v8, s[52:55], 0 offen offset:512 sc1
    buffer_store_dwordx4 v[44:47], v9, s[52:55], 0 offen offset:1024 sc1
    s_not_b64 exec, vcc
    buffer_store_dwordx4 v[36:39], v8, s[52:55], 0 offen offset:0
    buffer_store_dwordx4 v[40:43], v8, s[52:55], 0 offen offset:512
    buffer_store_dwordx4 v[44:47], v9, s[52:55], 0 offen offset:1024
    s_mov_b64 exec, 0xff
    s_mov_b32 s82, 163840
    s_waitcnt vmcnt(0)
    buffer_store_dwordx4 v[250:253], v254, s[44:47], s82 offen sc1
    s_mov_b64 exec, -1
    s_endpgm
L_yre1:
    s_sub_u32 s90, s90, 1
    s_cbranch_scc1 L_yok1
    v_cmp_eq_u32 s[4:5], -1, v36
    v_cmp_eq_u32 s[6:7], -1, v38
    v_cmp_eq_u32 s[8:9], -1, v40
    v_cmp_eq_u32 s[10:11], -1, v42
    v_cmp_eq_u32 s[12:13], -1, v44
    s_mov_b64 exec, s[4:5]
    buffer_load_dwordx2 v[36:37], v6, s[44:47], 0 offen sc1
    s_mov_b64 exec, s[6:7]
    buffer_load_dwordx2 v[38:39], v6, s[44:47], s76 offen sc1
    s_mov_b64 exec, s[8:9]
    buffer_load_dwordx2 v[40:41], v6, s[44:47], s77 offen sc1
    s_mov_b64 exec, s[10:11]
    buffer_load_dwordx2 v[42:43], v6, s[44:47], s78 offen sc1
    s_mov_b64 exec, s[12:13]
    buffer_load_dwordx2 v[44:45], v6, s[44:47], s79 offen sc1
    s_mov_b64 exec, -1
    s_waitcnt vmcnt(0)
    s_branch L_ychk1
L_modre1:
    s_sub_u32 s90, s90, 1
    s_cbranch_scc1 L_modok1
    buffer_load_dwordx4 v[208:211], v7, s[44:47], 0 offen offset:0 sc1
    buffer_load_dwordx4 v[212:215], v7, s[44:47], 0 offen offset:2560 sc1
    buffer_load_dwordx4 v[216:219], v7, s[44:47], s80 offen offset:0 sc1
    buffer_load_dwordx4 v[220:223], v7, s[44:47], s80 offen offset:2560 sc1
    buffer_load_dwordx4 v[224:227], v7, s[44:47], s81 offen offset:0 sc1
    buffer_load_dwordx4 v[228:231], v7, s[44:47], s81 offen offset:2560 sc1
    s_waitcnt vmcnt(0)
    s_branch L_modchk1
L_kv1:
    s_mov_b32 s90, 131072
L_kv1_re:
    buffer_load_dword v200, v10, s[44:47], 0 offen sc1
    s_waitcnt vmcnt(0)
    v_cmp_ne_u32 vcc, s75, v200
    s_cbranch_vccz L_kv1_ok
    s_sub_u32 s90, s90, 1
    s_cbranch_scc0 L_kv1_re
    s_branch L_kv1_ok
L_fc:
    s_mov_b32 s90, 131072
L_fc_re:
    buffer_load_dword v200, v3, s[44:47], 0 offen sc1
    s_waitcnt vmcnt(0)
    v_cmp_ne_u32 vcc, s75, v200
    s_cbranch_vccz L_fc_ok
    s_sub_u32 s90, s90, 1
    s_cbranch_scc0 L_fc_re
    s_branch L_fc_ok
L_kv0:
    buffer_load_dword v2, v74, s[44:47], 0 offen sc1
    s_waitcnt vmcnt(0)
    v_cmp_ne_u32 vcc, s75, v2
    s_cbranch_vccz L_kv0_ok
    s_sub_u32 s90, s90, 1
    s_cbranch_scc0 L_kv0
    s_branch L_kv0_ok
L_kv_far:
    v_and_b32 v2, 7, v1
    v_lshl_add_u32 v2, v2, 2, s86
    s_mov_b32 s90, 3
L_kv_again:
    global_load_dword v3, v2, s[32:33] sc1
    s_waitcnt vmcnt(0)
    v_cmp_ne_u32 vcc, s96, v3
    s_cbranch_vccnz L_kv_still
    s_mov_b32 s100, 0
    s_mov_b64 s[4:5], 1
    s_cmp_eq_u32 s99, 0
    s_cbranch_scc0 L_kv_nearc
    s_branch L_kv_nearn
L_kv_still:
    s_sub_u32 s90, s90, 1
    s_cbranch_scc0 L_kv_again
    buffer_store_dwordx2 v[190:191], v7, s[52:55], s82 offen sc1
    s_add_u32 s82, s82, 16384
    buffer_store_dwordx2 v[192:193], v7, s[52:55], s82 offen sc1
    s_add_u32 s82, s82, 16384
    buffer_store_dwordx2 v[194:195], v7, s[52:55], s82 offen sc1
    s_add_u32 s82, s82, 16384
    buffer_store_dwordx2 v[196:197], v7, s[52:55], s82 offen sc1
    s_add_u32 s82, s82, 16384
    buffer_store_dwordx2 v[198:199], v7, s[52:55], s82 offen sc1
    s_waitcnt vmcnt(0)
    s_mov_b64 exec, 1
    buffer_store_dword v12, v11, s[44:47], 0 offen sc1
    s_cmp_eq_u32 s99, 0
    s_cbranch_scc1 L_early_w3
    s_mov_b64 exec, -1
    s_branch L_pre
    .p2align 12
L_nconv:
    s_lshl_b32 s82, s2, 2
    s_add_u32 s82, s82, role_tab-L_pc-640
    s_load_dword s16, s[60:61], s82
    s_mov_b64 s[56:57], s[26:27]
    s_mov_b32 s58, 1280
    s_mov_b32 s59, 0x20000
    s_lshl_b32 s82, s74, 4
    v_min_u32 v2, 39, v1
    v_lshrrev_b32 v3, 1, v2
    v_mul_u32_u24 v3, 48, v3
    v_lshl_add_u32 v3, v2, 3, v3
    v_add_u32 v3, s82, v3
    buffer_load_dwordx2 v[220:221], v3, s[56:59], 0 offen
    s_mov_b64 s[44:45], s[34:35]
    s_mov_b32 s46, 9437184
    s_mov_b32 s47, 0x20000
    s_mov_b64 s[52:53], s[30:31]
    s_mov_b32 s54, 2621440
    s_mov_b32 s55, 0x20000
    s_mul_i32 s95, s72, 245760
    s_mul_i32 s89, s72, 81920
    s_add_u32 s89, s89, 1720320
    s_movk_i32 s79, 16384
    s_movk_i32 s80, 5120
    s_movk_i32 s81, 10240
    s_mov_b32 s91, 0xffff0000
    s_mov_b32 s92, 0x5040100
    s_mov_b32 s93, 0x7060302
    s_mov_b64 s[68:69], s[18:19]
    s_mov_b32 s70, 1280
    s_mov_b32 s71, 0x20000
    s_mul_i32 s96, s96, 0x01010101
    s_mov_b32 s97, s96
    s_cmp_lt_u32 s74, 3
    s_cselect_b32 s82, s95, s89
    s_mul_i32 s84, s74, 81920
    s_add_u32 s82, s82, s84
    s_lshl_b32 s84, s101, 7
    s_add_u32 s82, s82, s84
    v_and_b32 v140, 15, v1
    v_lshrrev_b32 v141, 4, v1
    v_lshl_add_u32 v7, v140, 3, s82
    v_lshl_add_u32 v7, v141, 12, v7
    s_mul_i32 s82, s74, 40
    s_add_u32 s82, s82, 89088
    v_xor_b32 v142, 1, v140
    v_mul_u32_u24 v142, 656, v142
    v_add_u32 v142, s82, v142
    v_mul_u32_u24 v143, 160, v141
    v_add_u32 v143, 11152, v143
    v_add_u32 v86, v142, v143
    v_lshrrev_b32 v143, 1, v141
    v_mul_u32_u24_e64 v143, 16, v143
    v_mul_u32_u24 v144, 320, v141
    v_add3_u32 v9, v142, v143, v144
    v_bfe_u32 v142, v1, 2, 2
    s_mul_i32 s82, s74, 160
    s_add_u32 s82, s82, 110848
    v_lshl_add_u32 v87, v142, 3, s82
    v_and_b32 v143, 3, v1
    v_lshl_add_u32 v144, v141, 1, v143
    v_sub_u32 v144, 7, v144
    v_add_u32 v145, -1, v144
    v_add_u32 v143, v143, v141
    v_lshlrev_b32 v142, 2, v1
    v_and_b32 v142, 16, v142
    s_mov_b32 s82, 0x0c0c0c0c
    s_movk_i32 s84, 0x202
    v_mov_b32 v146, 0x0d0c
    v_cmp_gt_u32 s[12:13], 4, v144
    v_cmp_gt_u32 s[14:15], 4, v145
    v_cmp_eq_u32 vcc, 3, v143
    v_mul_u32_u24 v144, s84, v144
    v_mul_u32_u24 v145, s84, v145
    v_xor_b32 v144, v144, v146
    v_xor_b32 v145, v145, v146
    v_mov_b32 v146, 0x3f80
    v_cndmask_b32 v144, 0, v144, s[12:13]
    v_cndmask_b32 v145, 0, v145, s[14:15]
    v_cndmask_b32 v146, 0, v146, vcc
    v_cmp_gt_u32 vcc, 8, v140
    v_lshlrev_b32 v144, v142, v144
    v_lshlrev_b32 v145, v142, v145
    v_lshlrev_b32 v146, v142, v146
    v_xor_b32 v144, s82, v144
    v_xor_b32 v145, s82, v145
    v_mov_b32 v143, s82
    v_cndmask_b32 v76, v143, v144, vcc
    v_cndmask_b32 v77, v144, v143, vcc
    v_cndmask_b32 v78, v143, v145, vcc
    v_cndmask_b32 v79, v145, v143, vcc
    v_mov_b32 v80, 0
    v_mov_b32 v81, 0
    v_mov_b32 v84, 0
    v_mov_b32 v85, 0
    v_cndmask_b32 v82, 0, v146, vcc
    v_cndmask_b32 v83, v146, v80, vcc
    s_lshl_b32 s82, s72, 2
    s_add_u32 s82, s82, s74
    s_lshl_b32 s82, s82, 5
    s_add_u32 s82, s82, s101
    s_lshl_b32 s82, s82, 2
    s_add_u32 s82, s82, 4096
    v_mov_b32 v11, s82
    s_movk_i32 s76, 4096
    s_movk_i32 s77, 8192
    s_movk_i32 s78, 12288
    s_mov_b64 s[60:61], s[28:29]
    s_mov_b32 s62, 4915200
    s_mov_b32 s63, 0x20000
    v_lshrrev_b32 v4, 4, v1
    v_bfe_u32 v5, v1, 2, 3
    v_and_b32 v6, 3, v1
    v_lshrrev_b32_e64 v2, 5, v1
    v_lshl_add_u32 v204, v2, 4, v5
    s_mul_i32 s82, s74, 1280
    s_add_u32 s82, s82, 83456
    v_lshl_add_u32 v207, v4, 4, s82
    v_lshlrev_b32 v208, 4, v1
    v_and_b32 v209, 15, v1
    v_lshlrev_b32 v210, 2, v209
    v_and_b32 v2, 1, v1
    v_bfe_u32 v205, v1, 1, 1
    v_lshl_or_b32 v205, v2, 1, v205
    v_and_b32 v2, -4, v1
    v_or_b32 v205, v2, v205
    v_lshlrev_b32 v205, 3, v205
    v_add_u32 v205, s82, v205
    v_lshrrev_b32 v2, 3, v1
    v_mul_u32_u24 v211, 7680, v2
    s_waitcnt lgkmcnt(0)
    s_add_u32 s75, s75, 1
    s_and_b32 s94, s75, 0xffff
    v_mov_b32 v12, s75
    s_and_b32 s17, s16, 3
    s_bfe_u32 s95, s16, 0x60002
    s_bfe_u32 s98, s16, 0x70008
    s_cmp_ge_u32 s98, 60
    s_cbranch_scc1 L_ad_help
    v_and_b32 v3, 6, v2
    v_xor_b32 v3, v3, v1
    v_and_b32 v3, 7, v3
    v_lshl_add_u32 v211, v3, 4, v211
    s_lshl_b32 s82, s98, 7
    v_add_u32 v211, s82, v211
    v_lshrrev_b32_e64 v2, 1, v5
    s_mul_i32 s82, s74, 20480
    v_lshl_add_u32 v212, v204, 7, s82
    v_lshl_add_u32 v212, v2, 5, v212
    v_lshl_add_u32 v212, v6, 3, v212
    v_xor_b32 v213, 32, v212
    v_xor_b32 v214, 64, v212
    v_xor_b32 v215, 0x60, v212
    s_branch L_ad_f
L_ad_help:
    s_bfe_u32 s84, s16, 0x3000f
    s_mul_i32 s82, s84, 32
    s_lshl_b32 s83, s74, 3
    s_add_u32 s83, s83, 640
    s_sub_u32 s82, s83, s82
    s_mul_i32 s82, s82, 7680
    s_bfe_u32 s85, s16, 0x60012
    s_lshl_b32 s83, s85, 7
    s_add_u32 s82, s82, s83
    s_bfe_u32 s87, s16, 0x30018
    v_and_b32 v2, 7, v1
    v_min_u32 v2, s87, v2
    v_lshl_add_u32 v211, v2, 7, v211
    v_add_u32 v211, s82, v211
    s_sub_u32 s82, 11, s87
    s_mul_i32 s82, s82, 32
    s_lshl_b32 s84, s84, 2
    s_sub_u32 s84, s84, s74
    s_mul_i32 s84, s84, 16
    s_add_u32 s82, s82, s84
    s_sub_u32 s82, 640, s82
    s_mul_i32 s82, s82, 7680
    s_add_u32 s82, s82, s83
    s_sub_u32 s85, 3, s85
    s_and_b32 s85, s85, 3
    s_add_u32 s83, s85, 4
    s_cmp_le_u32 s83, s87
    s_cselect_b32 s83, 512, 0
    s_lshl_b32 s85, s85, 7
    s_add_u32 s82, s82, s85
    v_min_u32 v2, 31, v1
    v_lshrrev_b32 v3, 1, v2
    v_mul_u32_u24 v3, 7680, v3
    v_and_b32 v2, 1, v2
    v_mad_u32_u24 v3, v2, s83, v3
    v_add_u32 v212, s82, v3
L_ad_f:
    s_cmp_eq_u32 s17, 2
    s_cbranch_scc1 L_ad_f2
    s_lshl_b32 s83, s95, 1
    v_lshrrev_b32 v2, 2, v1
    v_xor_b32 v3, v4, v1
    v_and_b32 v3, 1, v3
    v_and_or_b32 v3, v1, 2, v3
    v_xor_b32 v3, s83, v3
    v_and_b32 v3, 3, v3
    v_mul_u32_u24 v216, 3456, v2
    s_lshl_b32 s82, s95, 6
    v_add_u32 v216, s82, v216
    v_xor_b32 v2, 2, v3
    v_lshl_add_u32 v217, v2, 4, v216
    v_lshl_add_u32 v216, v3, 4, v216
    v_lshrrev_b32 v2, 1, v6
    v_and_b32 v3, 2, v6
    v_and_or_b32 v3, v4, 1, v3
    v_xor_b32 v3, s74, v3
    v_mul_u32_u24 v218, 40960, v2
    v_lshl_add_u32 v218, v204, 6, v218
    v_lshl_add_u32 v218, v3, 4, v218
    v_and_b32 v2, 1, v6
    v_lshl_add_u32 v218, v2, 3, v218
    v_mov_b32 v222, 0
    s_branch L_ad_done
L_ad_f2:
    v_lshrrev_b32 v2, 1, v1
    v_and_b32 v3, 1, v1
    v_mul_u32_u24 v216, 1280, v2
    v_lshl_add_u32 v216, v3, 4, v216
    s_lshl_b32 s82, s95, 5
    v_add_u32 v216, s82, v216
    v_mov_b32 v217, v216
    s_mul_i32 s82, s74, 14336
    v_lshl_add_u32 v218, v204, 5, s82
    v_lshl_add_u32 v218, v6, 3, v218
    v_mov_b32 v222, 0
L_ad_done:
    s_mov_b64 exec, 0
    s_cmp_eq_u32 s74, 3
    s_cbranch_scc1 L_padn0
L_backn:
    s_mov_b64 exec, -1
    s_load_dwordx8 s[4:11], s[32:33], s86
    s_waitcnt vmcnt(5) lgkmcnt(0)
    s_barrier
    ds_read_b64 v[64:65], v87 offset:0
    ds_read_b64 v[66:67], v87 offset:32
    ds_read_b64 v[68:69], v87 offset:64
    ds_read_b64 v[70:71], v87 offset:96
    ds_read_b64 v[72:73], v87 offset:128
    ds_read2_b64 v[16:19], v9 offset0:0 offset1:20
    ds_read2_b64 v[20:23], v9 offset0:1 offset1:21
    ds_read2_b64 v[24:27], v9 offset0:2 offset1:22
    ds_read2_b64 v[28:31], v9 offset0:3 offset1:23
    ds_read2_b64 v[32:35], v9 offset0:4 offset1:24
    s_waitcnt lgkmcnt(5)
    v_perm_b32 v36, v65, v64, v76
    v_perm_b32 v37, v65, v64, v77
    v_perm_b32 v38, v65, v64, v78
    v_perm_b32 v39, v65, v64, v79
    v_perm_b32 v40, v67, v66, v76
    v_perm_b32 v41, v67, v66, v77
    v_perm_b32 v42, v67, v66, v78
    v_perm_b32 v43, v67, v66, v79
    v_perm_b32 v44, v69, v68, v76
    v_perm_b32 v45, v69, v68, v77
    v_perm_b32 v46, v69, v68, v78
    v_perm_b32 v47, v69, v68, v79
    v_perm_b32 v48, v71, v70, v76
    v_perm_b32 v49, v71, v70, v77
    v_perm_b32 v50, v71, v70, v78
    v_perm_b32 v51, v71, v70, v79
    v_perm_b32 v52, v73, v72, v76
    v_perm_b32 v53, v73, v72, v77
    v_perm_b32 v54, v73, v72, v78
    v_perm_b32 v55, v73, v72, v79
    s_waitcnt lgkmcnt(0)
    v_mfma_f32_16x16x32_bf16 v[100:103], v[36:39], v[16:19], 0
    s_xor_b64 s[4:5], s[4:5], s[96:97]
    s_xor_b64 s[6:7], s[6:7], s[96:97]
    v_mfma_f32_16x16x32_bf16 v[104:107], v[40:43], v[20:23], 0
    s_xor_b64 s[8:9], s[8:9], s[96:97]
    s_xor_b64 s[10:11], s[10:11], s[96:97]
    v_mfma_f32_16x16x32_bf16 v[108:111], v[44:47], v[24:27], 0
    s_or_b64 s[4:5], s[4:5], s[6:7]
    s_or_b64 s[8:9], s[8:9], s[10:11]
    v_mfma_f32_16x16x32_bf16 v[112:115], v[48:51], v[28:31], 0
    s_or_b64 s[4:5], s[4:5], s[8:9]
    s_or_b32 s100, s4, s5
    v_mfma_f32_16x16x32_bf16 v[116:119], v[52:55], v[32:35], 0
    s_mov_b32 s82, 0
    s_waitcnt vmcnt(1) lgkmcnt(0)
    s_barrier
    ds_read2_b64 v[88:91], v86 offset0:0 offset1:1
    ds_read2_b64 v[92:95], v86 offset0:2 offset1:3
    ds_read2_b64 v[96:99], v86 offset0:4 offset1:4
    s_waitcnt lgkmcnt(0)
    v_mfma_f32_16x16x32_bf16 v[120:123], v[82:85], v[88:91], 0
    v_mfma_f32_16x16x32_bf16 v[124:127], v[80:83], v[88:91], 0
    v_mfma_f32_16x16x32_bf16 v[128:131], v[82:85], v[92:95], 0
    v_mfma_f32_16x16x32_bf16 v[132:135], v[80:83], v[92:95], 0
    v_mfma_f32_16x16x32_bf16 v[136:139], v[82:85], v[96:99], 0
    s_nop 3
    v_pk_mul_f32 v[100:101], v[100:101], v[120:121]
    v_pk_mul_f32 v[102:103], v[102:103], v[122:123]
    v_cvt_pk_bf16_f32 v190, v100, v101
    v_cvt_pk_bf16_f32 v191, v102, v103
    v_pk_mul_f32 v[104:105], v[104:105], v[124:125]
    v_pk_mul_f32 v[106:107], v[106:107], v[126:127]
    v_cvt_pk_bf16_f32 v192, v104, v105
    v_cvt_pk_bf16_f32 v193, v106, v107
    v_pk_mul_f32 v[108:109], v[108:109], v[128:129]
    v_pk_mul_f32 v[110:111], v[110:111], v[130:131]
    v_cvt_pk_bf16_f32 v194, v108, v109
    v_cvt_pk_bf16_f32 v195, v110, v111
    v_pk_mul_f32 v[112:113], v[112:113], v[132:133]
    v_pk_mul_f32 v[114:115], v[114:115], v[134:135]
    v_cvt_pk_bf16_f32 v196, v112, v113
    v_cvt_pk_bf16_f32 v197, v114, v115
    v_pk_mul_f32 v[116:117], v[116:117], v[136:137]
    v_pk_mul_f32 v[118:119], v[118:119], v[138:139]
    v_cvt_pk_bf16_f32 v198, v116, v117
    v_cvt_pk_bf16_f32 v199, v118, v119
    s_cmp_lg_u32 s100, 0
    s_cbranch_scc1 L_kv_far
L_kv_nearn:
    buffer_store_dwordx2 v[190:191], v7, s[52:55], s82 offen
    s_add_u32 s82, s82, 16384
    buffer_store_dwordx2 v[192:193], v7, s[52:55], s82 offen
    s_add_u32 s82, s82, 16384
    buffer_store_dwordx2 v[194:195], v7, s[52:55], s82 offen
    s_add_u32 s82, s82, 16384
    buffer_store_dwordx2 v[196:197], v7, s[52:55], s82 offen
    s_add_u32 s82, s82, 16384
    buffer_store_dwordx2 v[198:199], v7, s[52:55], s82 offen
    s_mov_b64 exec, 1
    s_waitcnt vmcnt(0)
    buffer_store_dword v12, v11, s[44:47], 0 offen
L_early_w3:
    s_mov_b64 exec, -1
    s_mul_i32 s84, s74, 20480
    s_mul_i32 s85, s74, 61440
    s_cmp_ge_u32 s98, 60
    s_barrier
    s_cbranch_scc1 L_help
    s_mov_b32 m0, s84
    s_mov_b32 s82, s85
    s_mov_b32 s83, 20
L_dma_1:
    buffer_load_dwordx4 v211, s[60:63], s82 offen lds
    s_add_u32 s82, s82, 245760
    s_add_u32 m0, m0, 1024
    s_sub_u32 s83, s83, 1
    s_cmp_lg_u32 s83, 0
    s_cbranch_scc1 L_dma_1
    v_lshlrev_b32 v24, 16, v220
    v_and_b32 v25, s91, v220
    v_lshlrev_b32 v26, 16, v221
    v_and_b32 v27, s91, v221
    v_mul_f32 v28, 0xbfb8aa3b, v24
    v_mul_f32 v29, 0xbfb8aa3b, v25
    v_mul_f32 v30, 0xbfb8aa3b, v26
    v_mul_f32 v31, 0xbfb8aa3b, v27
    v_exp_f32 v28, v28
    v_exp_f32 v29, v29
    v_exp_f32 v30, v30
    v_exp_f32 v31, v31
    v_add_f32 v28, 1.0, v28
    v_add_f32 v29, 1.0, v29
    v_add_f32 v30, 1.0, v30
    v_add_f32 v31, 1.0, v31
    v_rcp_f32 v28, v28
    v_rcp_f32 v29, v29
    v_rcp_f32 v30, v30
    v_rcp_f32 v31, v31
    v_mul_f32 v24, v24, v28
    v_mul_f32 v25, v25, v29
    v_mul_f32 v26, v26, v30
    v_mul_f32 v27, v27, v31
    v_cvt_pk_bf16_f32 v16, v24, v25
    v_cvt_pk_bf16_f32 v17, v26, v27
    ds_write_b64 v205, v[16:17]
    ds_read_b128 v[64:67], v207 offset:0
    ds_read_b128 v[68:71], v207 offset:64
    ds_read_b128 v[72:75], v207 offset:128
    ds_read_b128 v[76:79], v207 offset:192
    ds_read_b128 v[80:83], v207 offset:256
    v_cmp_le_u32 s[4:5], 16, v1
    v_cmp_le_u32 s[6:7], 32, v1
    v_cmp_le_u32 s[8:9], 48, v1
    v_lshlrev_b32 v2, 2, v1
    v_add_u32 v4, 89088, v2
    s_lshl_b32 s82, s74, 8
    v_add_u32 v5, s82, v4
    v_mov_b32 v3, s94
    s_lshl_b32 s82, s98, 8
    s_add_u32 s82, s82, 139264
    s_waitcnt vmcnt(16)
    ds_read_b64_tr_b16 v[96:97], v212 offset:0
    ds_read_b64_tr_b16 v[98:99], v212 offset:1024
    ds_read_b64_tr_b16 v[100:101], v213 offset:0
    ds_read_b64_tr_b16 v[102:103], v213 offset:1024
    ds_read_b64_tr_b16 v[104:105], v214 offset:0
    ds_read_b64_tr_b16 v[106:107], v214 offset:1024
    ds_read_b64_tr_b16 v[108:109], v215 offset:0
    ds_read_b64_tr_b16 v[110:111], v215 offset:1024
    s_waitcnt lgkmcnt(6)
    v_mfma_f32_16x16x32_bf16 v[32:35], v[64:67], v[96:99], 0
    s_waitcnt lgkmcnt(4)
    v_mfma_f32_16x16x32_bf16 v[36:39], v[64:67], v[100:103], 0
    s_waitcnt lgkmcnt(2)
    v_mfma_f32_16x16x32_bf16 v[40:43], v[64:67], v[104:107], 0
    s_waitcnt lgkmcnt(0)
    v_mfma_f32_16x16x32_bf16 v[44:47], v[64:67], v[108:111], 0
    s_waitcnt vmcnt(12)
    ds_read_b64_tr_b16 v[112:113], v212 offset:4096
    ds_read_b64_tr_b16 v[114:115], v212 offset:5120
    ds_read_b64_tr_b16 v[116:117], v213 offset:4096
    ds_read_b64_tr_b16 v[118:119], v213 offset:5120
    ds_read_b64_tr_b16 v[120:121], v214 offset:4096
    ds_read_b64_tr_b16 v[122:123], v214 offset:5120
    ds_read_b64_tr_b16 v[124:125], v215 offset:4096
    ds_read_b64_tr_b16 v[126:127], v215 offset:5120
    s_waitcnt lgkmcnt(6)
    v_mfma_f32_16x16x32_bf16 v[32:35], v[68:71], v[112:115], v[32:35]
    s_waitcnt lgkmcnt(4)
    v_mfma_f32_16x16x32_bf16 v[36:39], v[68:71], v[116:119], v[36:39]
    s_waitcnt lgkmcnt(2)
    v_mfma_f32_16x16x32_bf16 v[40:43], v[68:71], v[120:123], v[40:43]
    s_waitcnt lgkmcnt(0)
    v_mfma_f32_16x16x32_bf16 v[44:47], v[68:71], v[124:127], v[44:47]
    s_waitcnt vmcnt(8)
    ds_read_b64_tr_b16 v[128:129], v212 offset:8192
    ds_read_b64_tr_b16 v[130:131], v212 offset:9216
    ds_read_b64_tr_b16 v[132:133], v213 offset:8192
    ds_read_b64_tr_b16 v[134:135], v213 offset:9216
    ds_read_b64_tr_b16 v[136:137], v214 offset:8192
    ds_read_b64_tr_b16 v[138:139], v214 offset:9216
    ds_read_b64_tr_b16 v[140:141], v215 offset:8192
    ds_read_b64_tr_b16 v[142:143], v215 offset:9216
    s_waitcnt lgkmcnt(6)
    v_mfma_f32_16x16x32_bf16 v[32:35], v[72:75], v[128:131], v[32:35]
    s_waitcnt lgkmcnt(4)
    v_mfma_f32_16x16x32_bf16 v[36:39], v[72:75], v[132:135], v[36:39]
    s_waitcnt lgkmcnt(2)
    v_mfma_f32_16x16x32_bf16 v[40:43], v[72:75], v[136:139], v[40:43]
    s_waitcnt lgkmcnt(0)
    v_mfma_f32_16x16x32_bf16 v[44:47], v[72:75], v[140:143], v[44:47]
    s_waitcnt vmcnt(4)
    ds_read_b64_tr_b16 v[144:145], v212 offset:12288
    ds_read_b64_tr_b16 v[146:147], v212 offset:13312
    ds_read_b64_tr_b16 v[148:149], v213 offset:12288
    ds_read_b64_tr_b16 v[150:151], v213 offset:13312
    ds_read_b64_tr_b16 v[152:153], v214 offset:12288
    ds_read_b64_tr_b16 v[154:155], v214 offset:13312
    ds_read_b64_tr_b16 v[156:157], v215 offset:12288
    ds_read_b64_tr_b16 v[158:159], v215 offset:13312
    s_waitcnt lgkmcnt(6)
    v_mfma_f32_16x16x32_bf16 v[32:35], v[76:79], v[144:147], v[32:35]
    s_waitcnt lgkmcnt(4)
    v_mfma_f32_16x16x32_bf16 v[36:39], v[76:79], v[148:151], v[36:39]
    s_waitcnt lgkmcnt(2)
    v_mfma_f32_16x16x32_bf16 v[40:43], v[76:79], v[152:155], v[40:43]
    s_waitcnt lgkmcnt(0)
    v_mfma_f32_16x16x32_bf16 v[44:47], v[76:79], v[156:159], v[44:47]
    s_waitcnt vmcnt(0)
    ds_read_b64_tr_b16 v[160:161], v212 offset:16384
    ds_read_b64_tr_b16 v[162:163], v212 offset:17408
    ds_read_b64_tr_b16 v[164:165], v213 offset:16384
    ds_read_b64_tr_b16 v[166:167], v213 offset:17408
    ds_read_b64_tr_b16 v[168:169], v214 offset:16384
    ds_read_b64_tr_b16 v[170:171], v214 offset:17408
    ds_read_b64_tr_b16 v[172:173], v215 offset:16384
    ds_read_b64_tr_b16 v[174:175], v215 offset:17408
    s_waitcnt lgkmcnt(6)
    v_mfma_f32_16x16x32_bf16 v[32:35], v[80:83], v[160:163], v[32:35]
    s_waitcnt lgkmcnt(4)
    v_mfma_f32_16x16x32_bf16 v[36:39], v[80:83], v[164:167], v[36:39]
    s_waitcnt lgkmcnt(2)
    v_mfma_f32_16x16x32_bf16 v[40:43], v[80:83], v[168:171], v[40:43]
    s_waitcnt lgkmcnt(0)
    v_mfma_f32_16x16x32_bf16 v[44:47], v[80:83], v[172:175], v[44:47]
    s_nop 3
    v_cndmask_b32 v16, v32, v36, s[4:5]
    s_nop 0
    v_cndmask_b32 v16, v16, v40, s[6:7]
    s_nop 0
    v_cndmask_b32 v16, v16, v44, s[8:9]
    ds_write_b32 v5, v16
    s_cmp_lg_u32 s74, 0
    s_waitcnt lgkmcnt(0)
    s_barrier
    s_cbranch_scc1 L_mod_done
    ds_read2st64_b32 v[16:17], v4 offset0:0 offset1:1
    ds_read2st64_b32 v[18:19], v4 offset0:2 offset1:3
    s_waitcnt lgkmcnt(0)
    v_add_f32 v16, v16, v17
    v_add_f32 v18, v18, v19
    v_add_f32 v16, v16, v18
    v_cvt_pk_bf16_f32 v16, v16, v16
    v_and_or_b32 v16, v16, s91, v3
    buffer_store_dword v16, v2, s[44:47], s82 offen sc1
L_mod_done:
    s_barrier
L_nomod:
    s_mov_b32 s58, 2211840
    s_cmp_eq_u32 s17, 2
    s_cbranch_scc1 L_f2w
    s_cmp_eq_u32 s17, 1
    s_cbranch_scc0 L_other
    s_lshl_b32 s82, s95, 7
    s_add_u32 s82, s82, 65536
    v_lshrrev_b32 v2, 3, v1
    v_mul_u32_u24 v2, 7040, v2
    v_add3_u32 v7, v2, v208, s82
    s_cmp_lg_u32 s74, 0
    s_cbranch_scc1 L_nohw
    v_not_b32 v16, s75
    v_not_b32 v17, s75
    v_not_b32 v18, s75
    v_not_b32 v19, s75
    buffer_store_dwordx4 v[16:19], v7, s[44:47], 0 offen sc1
L_nohw:
    s_lshl_b32 s87, s74, 10
    s_mul_i32 s85, s74, 55296
    s_bitcmp1_b32 s95, 0
    s_cselect_b64 s[56:57], s[22:23], s[20:21]
    s_cselect_b64 s[60:61], s[20:21], s[22:23]
    s_cselect_b32 s86, 40960, 0
    s_mov_b32 s62, 2211840
    s_add_u32 s84, s87, s86
    s_mov_b32 m0, s84
    s_mov_b32 s82, s85
    s_mov_b32 s83, 10
L_dma_2:
    buffer_load_dwordx4 v216, s[56:59], s82 offen lds
    s_add_u32 s82, s82, 221184
    s_add_u32 m0, m0, 4096
    s_sub_u32 s83, s83, 1
    s_cmp_lg_u32 s83, 0
    s_cbranch_scc1 L_dma_2
    s_sub_u32 s84, s87, s86
    s_add_u32 s84, s84, 40960
    s_bitcmp1_b32 s95, 0
    s_cselect_b32 s86, 4, -4
    s_cselect_b32 s87, 0, 36
    s_mul_i32 s82, s87, 55296
    s_add_u32 s85, s85, s82
    s_lshl_b32 s87, s87, 10
    s_add_u32 s84, s84, s87
    s_lshl_b32 s87, s86, 10
    s_mul_i32 s86, s86, 55296
    s_mov_b32 m0, s84
    s_mov_b32 s82, s85
    s_mov_b32 s83, 10
L_dma_3:
    buffer_load_dwordx4 v217, s[60:63], s82 offen lds
    s_add_u32 s82, s82, s86
    s_add_u32 m0, m0, s87
    s_sub_u32 s83, s83, 1
    s_cmp_lg_u32 s83, 0
    s_cbranch_scc1 L_dma_3
    v_min_u32 v4, 39, v1
    s_mul_i32 s82, s74, 40
    v_add_u32 v4, s82, v4
    v_lshlrev_b32 v13, 7, v4
    v_lshlrev_b32 v12, 4, v4
    v_add_u32 v12, 196608, v12
    s_mul_i32 s83, s72, 20480
    s_add_u32 s83, s83, 655360
    v_mov_b32 v11, 88576
    v_mov_b32_e64 v2, 0
    ds_write_b32 v11, v2
    s_mov_b32 s84, 0x10001
    s_mov_b32 s85, 0x10001
    v_bfe_u32 v2, v4, 4, 1
    v_and_b32 v3, 15, v4
    v_lshl_add_u32 v2, v3, 1, v2
    v_and_b32 v3, 0xe0, v4
    v_or_b32 v3, v3, v2
    s_movk_i32 s86, 2560
    s_mov_b32 s82, 83456
    v_and_b32 v2, 1, v3
    v_bfe_u32 v205, v3, 1, 1
    v_lshl_or_b32 v205, v2, 1, v205
    v_and_b32 v2, -4, v3
    v_or_b32 v205, v2, v205
    v_lshlrev_b32 v205, 3, v205
    v_lshrrev_b32 v205, 1, v205
    v_add_u32 v205, s82, v205
    v_and_b32 v2, 1, v1
    v_mul_u32_u24 v15, 0xaaaa, v2
    v_add_u32 v15, 0x4444, v15
    v_mul_u32_u24 v2, 704, v2
    v_and_b32 v207, 48, v1
    v_add3_u32 v207, v207, v2, s82
    v_mov_b32 v40, 0
    v_mov_b32 v41, 0
    v_mov_b32 v42, 0
    v_mov_b32 v43, 0
    s_mov_b32 s87, 63488
    s_lshl_b32 s82, s74, 5
    s_add_u32 s82, s82, 88704
    v_lshl_add_u32 v5, v1, 2, s82
    v_and_b32 v8, 0x70, v208
    v_add_u32 v8, 88704, v8
    v_mov_b32_e64 v6, s94
    s_waitcnt vmcnt(0) lgkmcnt(0)
    s_barrier
    buffer_load_dwordx2 v[16:17], v13, s[44:47], s83 offen sc1
    ds_read_b64_tr_b16 a[0:1], v218 offset:0
    ds_read_b64_tr_b16 a[2:3], v218 offset:512
    ds_read_b64_tr_b16 a[4:5], v218 offset:2048
    ds_read_b64_tr_b16 a[6:7], v218 offset:2560
    ds_read_b64_tr_b16 a[8:9], v218 offset:4096
    ds_read_b64_tr_b16 a[10:11], v218 offset:4608
    ds_read_b64_tr_b16 a[12:13], v218 offset:6144
    ds_read_b64_tr_b16 a[14:15], v218 offset:6656
    ds_read_b64_tr_b16 a[16:17], v218 offset:8192
    ds_read_b64_tr_b16 a[18:19], v218 offset:8704
    ds_read_b64_tr_b16 a[20:21], v218 offset:10240
    ds_read_b64_tr_b16 a[22:23], v218 offset:10752
    ds_read_b64_tr_b16 a[24:25], v218 offset:12288
    ds_read_b64_tr_b16 a[26:27], v218 offset:12800
    ds_read_b64_tr_b16 a[28:29], v218 offset:14336
    ds_read_b64_tr_b16 a[30:31], v218 offset:14848
    ds_read_b64_tr_b16 a[32:33], v218 offset:16384
    ds_read_b64_tr_b16 a[34:35], v218 offset:16896
    ds_read_b64_tr_b16 a[36:37], v218 offset:18432
    ds_read_b64_tr_b16 a[38:39], v218 offset:18944
    ds_read_b64_tr_b16 a[40:41], v218 offset:20480
    ds_read_b64_tr_b16 a[42:43], v218 offset:20992
    ds_read_b64_tr_b16 a[44:45], v218 offset:22528
    ds_read_b64_tr_b16 a[46:47], v218 offset:23040
    ds_read_b64_tr_b16 a[48:49], v218 offset:24576
    ds_read_b64_tr_b16 a[50:51], v218 offset:25088
    ds_read_b64_tr_b16 a[52:53], v218 offset:26624
    ds_read_b64_tr_b16 a[54:55], v218 offset:27136
    ds_read_b64_tr_b16 a[56:57], v218 offset:28672
    ds_read_b64_tr_b16 a[58:59], v218 offset:29184
    ds_read_b64_tr_b16 a[60:61], v218 offset:30720
    ds_read_b64_tr_b16 a[62:63], v218 offset:31232
    ds_read_b64_tr_b16 a[64:65], v218 offset:32768
    ds_read_b64_tr_b16 a[66:67], v218 offset:33280
    ds_read_b64_tr_b16 a[68:69], v218 offset:34816
    ds_read_b64_tr_b16 a[70:71], v218 offset:35328
    ds_read_b64_tr_b16 a[72:73], v218 offset:36864
    ds_read_b64_tr_b16 a[74:75], v218 offset:37376
    ds_read_b64_tr_b16 a[76:77], v218 offset:38912
    ds_read_b64_tr_b16 a[78:79], v218 offset:39424
    s_branch L_keys
L_help:
    s_mov_b32 s82, 0
    buffer_load_dword v239, v212, s[60:63], 0 offen
    buffer_load_dword v240, v211, s[60:63], s82 offen
    s_add_u32 s82, s82, 245760
    s_branch L_nomod
L_f2w:
    s_mov_b64 s[56:57], s[24:25]
    s_cmp_eq_u32 s74, 3
    s_cselect_b32 s86, 12, 14
    s_lshr_b32 s87, s16, 27
    s_sub_u32 s86, s86, s87
    s_mul_i32 s89, s74, 14
    s_add_u32 s84, s89, s87
    s_mul_i32 s85, s84, 40960
    s_lshl_b32 s84, s84, 10
    s_mov_b32 m0, s84
    s_mov_b32 s82, s85
    s_mov_b32 s83, s86
L_dma_4:
    buffer_load_dwordx4 v216, s[56:59], s82 offen lds
    s_add_u32 s82, s82, 40960
    s_add_u32 m0, m0, 1024
    s_sub_u32 s83, s83, 1
    s_cmp_lg_u32 s83, 0
    s_cbranch_scc1 L_dma_4
    s_mul_i32 s85, s89, 40960
    s_lshl_b32 s84, s89, 10
    s_mov_b32 m0, s84
    s_mov_b32 s82, s85
    s_mov_b32 s83, s87
L_dma_5:
    buffer_load_dwordx4 v216, s[56:59], s82 offen lds
    s_add_u32 s82, s82, 40960
    s_add_u32 m0, m0, 1024
    s_sub_u32 s83, s83, 1
    s_cmp_lg_u32 s83, 0
    s_cbranch_scc1 L_dma_5
    v_mov_b32 v16, 0
    v_mov_b32 v17, 0
    v_mov_b32 v18, 0
    v_mov_b32 v19, 0
    ds_write_b128 v208, v[16:19] offset:55296
    ds_write_b128 v208, v[16:19] offset:56320
    s_mul_i32 s85, s74, 1792
    s_mul_i32 s82, s72, 7168
    s_add_u32 s85, s85, s82
    s_add_u32 s85, s85, 65536
L_padn0:
    s_cbranch_execz L_backn
    s_cmp_eq_u32 s74, 3
    s_cselect_b32 s82, 31, 47
    v_min_u32 v12, s82, v1
    v_lshlrev_b32 v12, 4, v12
    v_lshlrev_b32 v14, 1, v209
    s_lshl_b32 s82, s74, 6
    s_add_u32 s82, s82, 88576
    v_add_u32 v11, s82, v210
    v_add_u32 v13, 88576, v210
    s_lshl_b32 s84, s95, 6
    s_add_u32 s84, s84, 152064
    s_lshl_b32 s82, s72, 7
    s_add_u32 s82, s82, 63488
    v_mov_b32 v10, s82
    s_mul_i32 s82, s74, 1280
    s_add_u32 s82, s82, 83456
    v_subrev_u32 v205, s82, v205
    v_lshrrev_b32 v205, 1, v205
    v_add_u32 v205, s82, v205
    v_and_b32 v2, 1, v1
    v_mul_u32_u24 v15, 0xaaaa, v2
    v_add_u32 v15, 0x4444, v15
    v_mul_u32_u24 v2, 704, v2
    v_and_b32 v207, 48, v1
    v_add3_u32 v207, v207, v2, s82
    v_mov_b32 v40, 0
    v_mov_b32 v41, 0
    v_mov_b32 v42, 0
    v_mov_b32 v43, 0
    s_waitcnt vmcnt(0)
    ds_read_b64_tr_b16 a[0:1], v218 offset:0
    ds_read_b64_tr_b16 a[2:3], v218 offset:256
    ds_read_b64_tr_b16 a[4:5], v218 offset:1024
    ds_read_b64_tr_b16 a[6:7], v218 offset:1280
    ds_read_b64_tr_b16 a[8:9], v218 offset:2048
    ds_read_b64_tr_b16 a[10:11], v218 offset:2304
    ds_read_b64_tr_b16 a[12:13], v218 offset:3072
    ds_read_b64_tr_b16 a[14:15], v218 offset:3328
    ds_read_b64_tr_b16 a[16:17], v218 offset:4096
    ds_read_b64_tr_b16 a[18:19], v218 offset:4352
    ds_read_b64_tr_b16 a[20:21], v218 offset:5120
    ds_read_b64_tr_b16 a[22:23], v218 offset:5376
    ds_read_b64_tr_b16 a[24:25], v218 offset:6144
    ds_read_b64_tr_b16 a[26:27], v218 offset:6400
    ds_read_b64_tr_b16 a[28:29], v218 offset:7168
    ds_read_b64_tr_b16 a[30:31], v218 offset:7424
    ds_read_b64_tr_b16 a[32:33], v218 offset:8192
    ds_read_b64_tr_b16 a[34:35], v218 offset:8448
    ds_read_b64_tr_b16 a[36:37], v218 offset:9216
    ds_read_b64_tr_b16 a[38:39], v218 offset:9472
    ds_read_b64_tr_b16 a[40:41], v218 offset:10240
    ds_read_b64_tr_b16 a[42:43], v218 offset:10496
    ds_read_b64_tr_b16 a[44:45], v218 offset:11264
    ds_read_b64_tr_b16 a[46:47], v218 offset:11520
    ds_read_b64_tr_b16 a[48:49], v218 offset:12288
    ds_read_b64_tr_b16 a[50:51], v218 offset:12544
    ds_read_b64_tr_b16 a[52:53], v218 offset:13312
    ds_read_b64_tr_b16 a[54:55], v218 offset:13568
    s_mov_b64 exec, 1
    s_mov_b32 s90, 131072
L_fwd_6:
    buffer_load_dwordx4 v[16:19], v10, s[44:47], 0 offen sc1
    s_waitcnt vmcnt(0) lgkmcnt(0)
    v_xor_b32 v2, s75, v17
    v_bitop3_b32 v2, v2, v19, s75 bitop3:0xf6
    v_cmp_ne_u32 vcc, 0, v2
    s_cbranch_vccz L_fwd_6_ok
    s_sub_u32 s90, s90, 1
    s_cbranch_scc0 L_fwd_6
L_fwd_6_ok:
    v_readfirstlane_b32 s89, v16
    v_readfirstlane_b32 s88, v18
    s_mov_b64 exec, -1
    s_branch L_f2
L_other:
    s_cmp_eq_u32 s17, 3
    s_cbranch_scc0 L_fin
    v_lshrrev_b32 v13, 1, v208
    s_mov_b32 s83, 146944
    buffer_load_dwordx2 v[32:33], v13, s[68:71], 0 offen offset:0
    buffer_load_dwordx2 v[34:35], v13, s[68:71], 0 offen offset:512
    buffer_load_dwordx2 v[36:37], v13, s[68:71], 0 offen offset:1024
    s_mov_b32 s90, 131072
L_sb_7:
    buffer_load_dwordx4 v[16:19], v208, s[44:47], s83 offen offset:0 sc1
    buffer_load_dwordx4 v[20:23], v208, s[44:47], s83 offen offset:1024 sc1
    buffer_load_dwordx4 v[24:27], v208, s[44:47], s83 offen offset:2048 sc1
    s_waitcnt vmcnt(0)
    v_xor_b32 v2, s94, v16
    v_bitop3_b32 v2, v2, v17, s94 bitop3:0xf6
    v_bitop3_b32 v2, v2, v18, s94 bitop3:0xf6
    v_bitop3_b32 v2, v2, v19, s94 bitop3:0xf6
    v_bitop3_b32 v2, v2, v20, s94 bitop3:0xf6
    v_bitop3_b32 v2, v2, v21, s94 bitop3:0xf6
    v_bitop3_b32 v2, v2, v22, s94 bitop3:0xf6
    v_bitop3_b32 v2, v2, v23, s94 bitop3:0xf6
    v_bitop3_b32 v2, v2, v24, s94 bitop3:0xf6
    v_bitop3_b32 v2, v2, v25, s94 bitop3:0xf6
    v_bitop3_b32 v2, v2, v26, s94 bitop3:0xf6
    v_bitop3_b32 v2, v2, v27, s94 bitop3:0xf6
    v_and_b32 v2, 0xffff, v2
    v_cmp_ne_u32 vcc, 0, v2
    s_cbranch_vccz L_sb_7_ok
    s_sub_u32 s90, s90, 1
    s_cbranch_scc0 L_sb_7
L_sb_7_ok:
    v_and_b32 v16, s91, v16
    v_and_b32 v17, s91, v17
    v_and_b32 v18, s91, v18
    v_and_b32 v19, s91, v19
    v_and_b32 v20, s91, v20
    v_and_b32 v21, s91, v21
    v_and_b32 v22, s91, v22
    v_and_b32 v23, s91, v23
    v_and_b32 v24, s91, v24
    v_and_b32 v25, s91, v25
    v_and_b32 v26, s91, v26
    v_and_b32 v27, s91, v27
    v_lshlrev_b32 v52, 16, v32
    v_and_b32 v53, s91, v32
    v_lshlrev_b32 v54, 16, v33
    v_and_b32 v55, s91, v33
    v_lshlrev_b32 v56, 16, v34
    v_and_b32 v57, s91, v34
    v_lshlrev_b32 v58, 16, v35
    v_and_b32 v59, s91, v35
    v_lshlrev_b32 v60, 16, v36
    v_and_b32 v61, s91, v36
    v_lshlrev_b32 v62, 16, v37
    v_and_b32 v63, s91, v37
    v_pk_mul_f32 v[28:29], v[16:17], v[52:53]
    v_pk_fma_f32 v[28:29], v[18:19], v[54:55], v[28:29]
    v_pk_fma_f32 v[28:29], v[20:21], v[56:57], v[28:29]
    v_pk_fma_f32 v[28:29], v[22:23], v[58:59], v[28:29]
    v_pk_fma_f32 v[28:29], v[24:25], v[60:61], v[28:29]
    v_pk_fma_f32 v[28:29], v[26:27], v[62:63], v[28:29]
    v_add_f32 v51, v28, v29
    s_nop 1
    v_add_f32_dpp v51, v51, v51 row_ror:8 row_mask:0xf bank_mask:0xf
    s_nop 1
    v_add_f32_dpp v51, v51, v51 row_ror:4 row_mask:0xf bank_mask:0xf
    s_nop 1
    v_add_f32_dpp v51, v51, v51 row_ror:2 row_mask:0xf bank_mask:0xf
    s_nop 1
    v_add_f32_dpp v51, v51, v51 row_ror:1 row_mask:0xf bank_mask:0xf
    v_mov_b32 v28, v51
    s_nop 1
    v_permlane16_swap_b32 v28, v51
    v_add_f32 v51, v28, v51
    v_mov_b32 v28, v51
    s_nop 1
    v_permlane32_swap_b32 v28, v51
    v_add_f32 v18, v28, v51
    v_mov_b32 v19, s75
    v_min_u32 v4, 39, v1
    s_mul_i32 s82, s74, 40
    v_add_u32 v4, s82, v4
    v_lshlrev_b32 v13, 7, v4
    v_lshlrev_b32_e64 v12, 4, v4
    v_add_u32 v12, 196608, v12
    s_mul_i32 s83, s72, 20480
    s_add_u32 s83, s83, 655360
    v_mov_b32 v11, 88576
    v_mov_b32_e64 v2, 0
    ds_write_b32 v11, v2
    s_mov_b32 s84, 0x10001
    s_mov_b32 s85, 0x10001
    v_bfe_u32 v2, v4, 4, 1
    v_and_b32 v3, 15, v4
    v_lshl_add_u32 v2, v3, 1, v2
    v_and_b32 v3, 0xe0, v4
    v_or_b32 v3, v3, v2
    s_movk_i32 s86, 2560
    s_mov_b32 s82, 83456
    v_and_b32 v2, 1, v3
    v_bfe_u32 v205, v3, 1, 1
    v_lshl_or_b32 v205, v2, 1, v205
    v_and_b32 v2, -4, v3
    v_or_b32 v205, v2, v205
    v_lshlrev_b32 v205, 3, v205
    v_lshrrev_b32 v205, 1, v205
    v_add_u32 v205, s82, v205
    v_and_b32 v2, 1, v1
    v_mul_u32_u24 v15, 0xaaaa, v2
    v_add_u32 v15, 0x4444, v15
    v_mul_u32_u24 v2, 704, v2
    v_and_b32 v207, 48, v1
    v_add3_u32 v207, v207, v2, s82
    v_mov_b32 v40, 0
    v_mov_b32 v41, 0
    v_mov_b32 v42, 0
    v_mov_b32 v43, 0
    s_mov_b32 s87, 63488
    s_lshl_b32 s82, s74, 5
    s_add_u32 s82, s82, 88704
    v_lshl_add_u32 v5, v1, 2, s82
    v_and_b32 v8, 0x70, v208
    v_add_u32 v8, 88704, v8
    v_mov_b32 v6, s94
    s_waitcnt lgkmcnt(0)
    s_barrier
    buffer_load_dwordx2 v[16:17], v13, s[44:47], s83 offen sc1
L_keys:
    s_mov_b32 s90, 131072
    s_branch L_keychk
L_key:
    buffer_load_dwordx2 v[16:17], v13, s[44:47], s83 offen sc1
L_keychk:
    s_waitcnt vmcnt(0)
    v_cmp_ne_u32 vcc, s75, v17
    s_cbranch_vccz L_key_ok
    s_mov_b64 exec, vcc
    s_sub_u32 s90, s90, 1
    s_cbranch_scc0 L_key
L_key_ok:
    s_mov_b64 exec, -1
    v_max_u32_dpp v16, v16, v16 row_ror:8 row_mask:0xf bank_mask:0xf
    s_nop 0
    s_nop 0
    v_max_u32_dpp v16, v16, v16 row_ror:4 row_mask:0xf bank_mask:0xf
    s_nop 1
    v_max_u32_dpp v16, v16, v16 row_ror:2 row_mask:0xf bank_mask:0xf
    s_nop 1
    v_max_u32_dpp v16, v16, v16 row_ror:1 row_mask:0xf bank_mask:0xf
    s_mov_b64 exec, s[84:85]
    ds_max_u32 v11, v16
    s_mov_b64 exec, -1
    s_waitcnt lgkmcnt(0)
    s_barrier
    ds_read_b32 v16, v11
    s_cmp_eq_u32 s17, 3
    s_waitcnt lgkmcnt(0)
    s_cbranch_scc1 L_fwd
    v_bfe_u32 v16, v16, 4, 8
    v_mad_u32_u24 v12, v16, s86, v12
    s_mov_b32 s90, 131072
L_row_8:
    buffer_load_dwordx4 v[16:19], v12, s[44:47], 0 offen sc1
    s_waitcnt vmcnt(0)
    v_perm_b32 v28, v17, v16, s93
    v_perm_b32 v29, v19, v18, s93
    ds_write2_b32 v205, v28, v29 offset0:0 offset1:176
    v_xor_b32 v2, s94, v16
    v_bitop3_b32 v2, v2, v19, s94 bitop3:0xf6
    v_and_b32 v2, 0xffff, v2
    v_cmp_ne_u32 vcc, 0, v2
    s_cbranch_vccz L_row_8_ok
    s_sub_u32 s90, s90, 1
    s_cbranch_scc0 L_row_8
L_row_8_ok:
    s_waitcnt lgkmcnt(0)
    s_barrier
    ds_read_b128 v[64:67], v207 offset:0
    ds_read_b128 v[68:71], v207 offset:64
    ds_read_b128 v[72:75], v207 offset:128
    ds_read_b128 v[76:79], v207 offset:192
    ds_read_b128 v[80:83], v207 offset:256
    ds_read_b128 v[84:87], v207 offset:320
    ds_read_b128 v[88:91], v207 offset:384
    ds_read_b128 v[92:95], v207 offset:448
    ds_read_b128 v[96:99], v207 offset:512
    ds_read_b128 v[100:103], v207 offset:576
    s_waitcnt lgkmcnt(9)
    v_smfmac_f32_16x16x64_bf16 v[40:43], v[64:67], a[0:7], v15
    s_waitcnt lgkmcnt(8)
    v_smfmac_f32_16x16x64_bf16 v[40:43], v[68:71], a[8:15], v15
    s_waitcnt lgkmcnt(7)
    v_smfmac_f32_16x16x64_bf16 v[40:43], v[72:75], a[16:23], v15
    s_waitcnt lgkmcnt(6)
    v_smfmac_f32_16x16x64_bf16 v[40:43], v[76:79], a[24:31], v15
    s_waitcnt lgkmcnt(5)
    v_smfmac_f32_16x16x64_bf16 v[40:43], v[80:83], a[32:39], v15
    s_waitcnt lgkmcnt(4)
    v_smfmac_f32_16x16x64_bf16 v[40:43], v[84:87], a[40:47], v15
    s_waitcnt lgkmcnt(3)
    v_smfmac_f32_16x16x64_bf16 v[40:43], v[88:91], a[48:55], v15
    s_waitcnt lgkmcnt(2)
    v_smfmac_f32_16x16x64_bf16 v[40:43], v[92:95], a[56:63], v15
    s_waitcnt lgkmcnt(1)
    v_smfmac_f32_16x16x64_bf16 v[40:43], v[96:99], a[64:71], v15
    s_waitcnt lgkmcnt(0)
    v_smfmac_f32_16x16x64_bf16 v[40:43], v[100:103], a[72:79], v15
    v_and_b32 v2, 7, v1
    v_mul_u32_u24 v2, 12, v2
    v_sub_u32 v7, v7, v2
    s_lshl_b32 s82, s74, 5
    s_nop 3
    v_add_f32 v42, v42, v43
    v_add_f32 v40, v40, v41
    s_nop 1
    v_mov_b32_dpp v42, v40 row_ror:8 row_mask:0xf bank_mask:0xc
    v_mul_f32 v44, 0xbfb8aa3b, v42
    v_exp_f32 v44, v44
    v_mul_f32_dpp v45, v40, v40 row_ror:8 row_mask:0xf bank_mask:0xf
    v_add_f32 v44, 1.0, v44
    v_rcp_f32 v44, v44
    s_nop 0
    v_mul_f32 v44, v44, v45
    v_cvt_pk_bf16_f32 v44, v44, v44
    v_and_or_b32 v44, v44, s91, v6
    buffer_store_dword v44, v7, s[44:47], s82 offen sc1
    s_endpgm
L_fwd:
    s_cmp_lg_u32 s74, 0
    s_cbranch_scc1 L_fin
    buffer_store_dwordx4 v[16:19], v208, s[44:47], s87 offen sc1
    s_endpgm
L_f2:
    s_bfe_u32 s87, s89, 0x80004
    s_min_u32 s87, s87, 159
    s_lshl_b32 s86, s87, 7
    s_add_u32 s86, s86, 819204
    s_mov_b32 s90, 131072
L_base_9:
    buffer_load_dword v52, v222, s[44:47], s86 offen sc1
    buffer_load_dword v50, v210, s[44:47], s84 offen sc1
    s_waitcnt vmcnt(0)
    v_xor_b32 v2, s94, v50
    v_and_b32 v2, 0xffff, v2
    v_bitop3_b32 v2, v2, v52, s75 bitop3:0xf6
    v_cmp_ne_u32 vcc, 0, v2
    s_cbranch_vccz L_base_9_ok
    s_sub_u32 s90, s90, 1
    s_cbranch_scc0 L_base_9
L_base_9_ok:
    s_mul_i32 s82, s87, 3277
    s_lshr_b32 s82, s82, 16
    s_mul_i32 s83, s82, 20
    s_sub_u32 s83, s87, s83
    s_lshr_b32 s4, s83, 1
    s_lshl_b32 s5, s82, 2
    s_add_u32 s4, s4, s5
    s_add_u32 s4, s4, 90
    s_mul_i32 s82, s82, 12
    s_add_u32 s82, s82, s83
    s_cmp_lt_u32 s83, 12
    s_cselect_b32 s82, s82, s4
    s_lshl_b32 s82, s82, 4
    s_and_b32 s83, s89, 15
    s_add_u32 s82, s82, s83
    s_mul_i32 s82, s82, 1280
    s_lshl_b32 s83, s95, 5
    s_add_u32 s6, s82, s83
    buffer_load_ushort v52, v14, s[52:55], s6 offen sc1
    s_ashr_i32 s82, s89, 31
    s_not_b32 s82, s82
    s_bitset1_b32 s82, 31
    s_xor_b32 s82, s82, s89
    s_and_b32 s82, s82, 0xfffff000
    v_mov_b32 v51, s88
    v_add_f32 v51, s82, v51
    v_mul_f32 v51, 0xbfb8aa3b, v51
    v_exp_f32 v51, v51
    s_nop 0
    v_add_f32 v51, 1.0, v51
    v_rcp_f32 v51, v51
    s_mov_b32 s90, 131072
L_hid:
    buffer_load_dwordx4 v[16:19], v208, s[44:47], s85 offen sc1
    buffer_load_dwordx4 v[20:23], v12, s[44:47], s85 offen offset:1024 sc1
    s_waitcnt vmcnt(0) lgkmcnt(0)
    v_perm_b32 v28, v17, v16, s93
    v_perm_b32 v29, v19, v18, s93
    ds_write2_b32 v205, v28, v29 offset0:0 offset1:176
    v_perm_b32 v30, v21, v20, s93
    v_perm_b32 v31, v23, v22, s93
    ds_write2_b32 v205, v30, v31 offset0:64 offset1:240
    ds_read_b128 v[64:67], v207 offset:0
    ds_read_b128 v[68:71], v207 offset:64
    ds_read_b128 v[72:75], v207 offset:128
    ds_read_b128 v[76:79], v207 offset:192
    ds_read_b128 v[80:83], v207 offset:256
    ds_read_b128 v[84:87], v207 offset:320
    ds_read_b128 v[88:91], v207 offset:384
    v_xor_b32_e64 v2, s94, v16
    v_bitop3_b32 v2, v2, v19, s94 bitop3:0xf6
    v_bitop3_b32 v2, v2, v20, s94 bitop3:0xf6
    v_bitop3_b32 v2, v2, v23, s94 bitop3:0xf6
    v_and_b32 v2, 0xffff, v2
    v_cmp_ne_u32 vcc, 0, v2
    s_cbranch_vccz L_hid_ok
    s_sub_u32 s90, s90, 1
    s_cbranch_scc0 L_hid
L_hid_ok:
    s_waitcnt lgkmcnt(6)
    v_smfmac_f32_16x16x64_bf16 v[40:43], v[64:67], a[0:7], v15
    s_waitcnt lgkmcnt(5)
    v_smfmac_f32_16x16x64_bf16 v[40:43], v[68:71], a[8:15], v15
    s_waitcnt lgkmcnt(4)
    v_smfmac_f32_16x16x64_bf16 v[40:43], v[72:75], a[16:23], v15
    s_waitcnt lgkmcnt(3)
    v_smfmac_f32_16x16x64_bf16 v[40:43], v[76:79], a[24:31], v15
    s_waitcnt lgkmcnt(2)
    v_smfmac_f32_16x16x64_bf16 v[40:43], v[80:83], a[32:39], v15
    s_waitcnt lgkmcnt(1)
    v_smfmac_f32_16x16x64_bf16 v[40:43], v[84:87], a[40:47], v15
    s_waitcnt lgkmcnt(0)
    v_smfmac_f32_16x16x64_bf16 v[40:43], v[88:91], a[48:55], v15
    v_and_b32 v50, s91, v50
    v_mul_f32 v51, v51, v50
    v_lshlrev_b32 v52, 16, v52
    s_nop 4
    v_add_f32 v40, v40, v41
    ds_write_b32 v11, v40
    s_waitcnt lgkmcnt(0)
    s_barrier
    s_cmp_lg_u32 s74, 0
    s_cbranch_scc1 L_f2_other
    ds_read2_b32 v[44:45], v13 offset0:0 offset1:16
    ds_read2_b32 v[46:47], v13 offset0:32 offset1:48
    s_waitcnt lgkmcnt(0)
    v_add_f32 v44, v44, v45
    v_add_f32 v46, v46, v47
    v_add_f32 v44, v44, v46
    v_fma_f32 v44, v44, v51, v52
    v_cvt_pk_bf16_f32 v44, v44, v44
    s_mov_b64 exec, 0xffff
    buffer_store_short v44, v14, s[52:55], s6 offen
    s_mov_b64 exec, -1
    s_endpgm
L_f2_other:
    s_lshl_b32 s82, s95, 2
    s_add_u32 s82, s82, s74
    s_cmp_lg_u32 s82, 1
    s_cbranch_scc1 L_fin
    v_mov_b32 v3, s75
    s_mov_b64 exec, 1
    buffer_store_dword v3, v1, s[44:47], 0 offen offset:0
    s_mov_b64 exec, -1
L_fin:
L_end:
    s_endpgm
.type role_tab,@object
role_tab:
    .long 0xe00e302
    .long 0xe1ce312
    .long 0xe38e322
    .long 0xf54e332
    .long 0xf74e342
    .long 0xf94e352
    .long 0xfb4e362
    .long 0xed4e372
    .long 0x2e000006
    .long 0x2e1c0716
    .long 0x2e380e26
    .long 0x2f541536
    .long 0x2f741d46
    .long 0x2f942556
    .long 0x2fb42d66
    .long 0x2ed43576
    .long 0x4600010a
    .long 0x461c081a
    .long 0x46380f2a
    .long 0x4754163a
    .long 0x47741e4a
    .long 0x4794265a
    .long 0x47b42e6a
    .long 0x46d4367a
    .long 0x5e00020e
    .long 0x5e1c091e
    .long 0x5e38102e
    .long 0x5f54173e
    .long 0x5f741f4e
    .long 0x5f94275e
    .long 0x5fb42f6e
    .long 0x5ed4377e
    .long 0xe016301
    .long 0xe1d6321
    .long 0xe396341
    .long 0xf556361
    .long 0xf756379
    .long 0xf956391
    .long 0xfb563a9
    .long 0xed563c1
    .long 0xe000305
    .long 0xe1c0a25
    .long 0xe381145
    .long 0xf541865
    .long 0xf74207d
    .long 0xf942895
    .long 0xfb430ad
    .long 0xed438c5
    .long 0xe01e309
    .long 0xe1de329
    .long 0xe39e349
    .long 0xf55e369
    .long 0xf75e381
    .long 0xf95e399
    .long 0xfb5e3b1
    .long 0xed5e3c9
    .long 0xe00040d
    .long 0xe1c0b2d
    .long 0xe38124d
    .long 0xf54196d
    .long 0xf742185
    .long 0xf94299d
    .long 0xfb431b5
    .long 0xed439cd
    .long 0xe026311
    .long 0xe1e6331
    .long 0xe3a6351
    .long 0xf566371
    .long 0xf766389
    .long 0xf9663a1
    .long 0xfb663b9
    .long 0xed663d1
    .long 0xe000515
    .long 0xe1c0c35
    .long 0xe381355
    .long 0xf541a75
    .long 0xf74228d
    .long 0xf942aa5
    .long 0xfb432bd
    .long 0xed43ad5
    .long 0xe02e319
    .long 0xe1ee339
    .long 0xe3ae359
    .long 0xf541b82
    .long 0x2774238a
    .long 0xf942b92
    .long 0x27b4339a
    .long 0xed43b00
    .long 0xe00061d
    .long 0xe1c0d3d
    .long 0xe38145d
    .long 0x47541c86
    .long 0x5f74248e
    .long 0x47942c96
    .long 0x5fb4349e
    .long 0xed6e303
.size role_tab, 384
.section .rodata,"a"
.p2align 6
.amdhsa_kernel adaLN_cond__ssm_conv_h3__moe_arch_mod__prompt_kernel
  .amdhsa_next_free_vgpr 512
  .amdhsa_next_free_sgpr 102
  .amdhsa_accum_offset 256
  .amdhsa_group_segment_fixed_size 0
  .amdhsa_kernarg_size 128
  .amdhsa_user_sgpr_count 2
  .amdhsa_user_sgpr_kernarg_segment_ptr 1
  .amdhsa_system_sgpr_workgroup_id_x 1
  .amdhsa_float_denorm_mode_32 3
.end_amdhsa_kernel
```
